```python
import torch

def _softmax(x, axis=-1):
    return torch.softmax(x, dim=axis)
def _gelu(x):
    return torch.nn.functional.gelu(x, approximate="tanh")
def _silu(x):
    return torch.nn.functional.silu(x)
def _sigmoid(x):
    return torch.sigmoid(x)
def _layernorm(x, axis=-1, eps=1e-5):
    m = x.mean(dim=axis, keepdim=True)
    v = x.var(dim=axis, keepdim=True, unbiased=False)
    return (x - m) / torch.sqrt(v + eps)
def _scatter_add(tgt, idx, src, axis=0):
    return tgt.clone().index_add_(axis, idx, src)
def _segment_sum(src, seg, n):
    out = torch.zeros((n,) + src.shape[1:], dtype=src.dtype)
    return out.index_add_(0, seg, src)
def _pad(x, pw):
    flat = tuple(v for pair in reversed(pw) for v in pair)
    return torch.nn.functional.pad(x, flat)

kernel_name = 'concat_heads__ssm_conv_s4__linear_kernel_hedgehog__prompt'

def setup_inputs():

    _w = (lambda a: (lambda t: t.to(torch.bfloat16) if t.is_floating_point() else t)(torch.as_tensor(a)))
    def _A_setup():
        B, L, D, N = 1, 2048, 512, 128
        A_re = -(lambda _x: torch.exp(torch.as_tensor(_x)))((lambda *s: torch.randn(*s, dtype=torch.bfloat16) * 3.2)(D, N))
        A_im = torch.pi * (lambda *s: torch.randn(*s, dtype=torch.bfloat16) * 0.2)(D, N)
        B_re = (lambda *s: torch.randn(*s, dtype=torch.bfloat16) * 0.4)(D, N)
        B_im = (lambda *s: torch.randn(*s, dtype=torch.bfloat16) * 0.4)(D, N)
        C_re = (lambda *s: torch.randn(*s, dtype=torch.bfloat16) * 0.4)(D, N)
        C_im = (lambda *s: torch.randn(*s, dtype=torch.bfloat16) * 0.4)(D, N)
        log_dt = (lambda *s: torch.randn(*s, dtype=torch.bfloat16) * 0.2)(D) * 0.5 - 4.0
        Dskip = (lambda *s: torch.randn(*s, dtype=torch.bfloat16) * 0.4)(D)
        return {
            "u": _w((lambda *s: torch.randn(*s, dtype=torch.bfloat16) * 0.05)(B, L, D)),
            "A_re": _w(A_re),
            "A_im": _w(A_im),
            "B_re": _w(B_re),
            "B_im": _w(B_im),
            "C_re": _w(C_re),
            "C_im": _w(C_im),
            "log_dt": _w(log_dt),
            "Dskip": _w(Dskip),
        }
    _A_in = _A_setup()

    def _B_setup():
        B, S, D, H = 1, 2048, 512, 32
        Dh = D // H
        return {
            "x": _w((lambda *s: torch.randn(*s, dtype=torch.bfloat16) * 0.4)(B, S, D)),
            "wqkv": _w((lambda *s: torch.randn(*s, dtype=torch.bfloat16) * 0.4)(D, 3 * D)),
            "w_phi": _w((lambda *s: torch.randn(*s, dtype=torch.bfloat16) * 0.4)(H, Dh, Dh) * (Dh ** -0.5)),
            "wo": _w((lambda *s: torch.randn(*s, dtype=torch.bfloat16) * 0.05)(D, D)),
        }
    _B_in = _B_setup()

    return {
        "A_u": _A_in["u"],
        "A_A_re": _A_in["A_re"],
        "A_A_im": _A_in["A_im"],
        "A_B_re": _A_in["B_re"],
        "A_B_im": _A_in["B_im"],
        "A_C_re": _A_in["C_re"],
        "A_C_im": _A_in["C_im"],
        "A_log_dt": _A_in["log_dt"],
        "A_Dskip": _A_in["Dskip"],
        "B_x": _B_in["x"],
        "B_wqkv": _B_in["wqkv"],
        "B_w_phi": _B_in["w_phi"],
        "B_wo": _B_in["wo"],
    }

def reference(A_u, A_A_re, A_A_im, A_B_re, A_B_im, A_C_re, A_C_im, A_log_dt, A_Dskip, B_x, B_wqkv, B_w_phi, B_wo):
    def _A_ref(u, A_re, A_im, B_re, B_im, C_re, C_im, log_dt, Dskip):
        Bsz, L, D = u.shape
        dt = torch.exp(log_dt)[:, None]
        A = A_re + 1j * A_im
        Bc = B_re + 1j * B_im
        Cc = C_re + 1j * C_im
        logdA = dt * A
        dB = dt * Bc
        l = (lambda x, dt: x.to(dt))(torch.arange(L), A_re.dtype)
        P = torch.exp(logdA[:, :, None] * l[None, None, :])
        K = torch.einsum("dn,dnl,dn->dl", Cc, P, dB).real
        L2 = 2 * L
        Kp = _pad(K, ((0, 0), (0, L)))
        up = (lambda x, *d: x.permute(*d))(u, 0, 2, 1)
        up = _pad(up, ((0, 0), (0, 0), (0, L)))
        Kf = (lambda x, axes=(-2,-1): torch.fft.rfft2(x.float(), dim=axes))(Kp[:, None, :], axes=(-2, -1))
        Uf = (lambda x, axes=(-2,-1): torch.fft.rfft2(x.float(), dim=axes))(up[:, :, None, :], axes=(-2, -1))
        Yf = Uf * Kf[None, :, :, :]
        y = (lambda x, s, axes=(-2,-1): torch.fft.irfft2(x, s=s, dim=axes).to(torch.bfloat16))(Yf, (1, L2), axes=(-2, -1))[:, :, 0, :L]
        y = (lambda x, *d: x.permute(*d))(y, 0, 2, 1) + u * Dskip[None, None, :]
        return y

    def _B_ref(x, wqkv, w_phi, wo):
        B, S, D = x.shape
        H = 32; Dh = D // H
        qkv = (lambda x, *d: x.permute(*d))((x @ wqkv).reshape(B, S, 3, H, Dh), 2, 0, 3, 1, 4)
        q, k, v = qkv[0], qkv[1], qkv[2]
        pq = torch.einsum("bhsd,hdf->bhsf", q, w_phi)
        pk = torch.einsum("bhsd,hdf->bhsf", k, w_phi)
        phi_q = torch.concatenate([_softmax(pq, axis=-1), _softmax(-pq, axis=-1)], axis=-1)
        phi_k = torch.concatenate([_softmax(pk, axis=-1), _softmax(-pk, axis=-1)], axis=-1)
        kv = torch.einsum("bhsf,bhsd->bhfd", phi_k, v)
        z  = torch.einsum("bhsf->bhf", phi_k)
        num = torch.einsum("bhqf,bhfd->bhqd", phi_q, kv)
        den = torch.einsum("bhqf,bhf->bhq", phi_q, z)[..., None] + 1e-6
        o = num / den
        return (lambda x, *d: x.permute(*d))(o, 0, 2, 1, 3).reshape(B, S, D) @ wo

    a = _A_ref(A_u, A_A_re, A_A_im, A_B_re, A_B_im, A_C_re, A_C_im, A_log_dt, A_Dskip)
    b = _B_ref(B_x, B_wqkv, B_w_phi, B_wo)
    return torch.concatenate([a, b], axis=-1)
```

```asm
; @launch grid=(512,1,1) block=(256,1,1) lds=81920
.amdgcn_target "amdgcn-amd-amdhsa--gfx950"
.text
.globl concat_heads__ssm_conv_s4__linear_kernel_hedgehog__prompt_kernel
.p2align 8
.type concat_heads__ssm_conv_s4__linear_kernel_hedgehog__prompt_kernel,@function
concat_heads__ssm_conv_s4__linear_kernel_hedgehog__prompt_kernel:
.set CODE_BYTES, K_last-concat_heads__ssm_conv_s4__linear_kernel_hedgehog__prompt_kernel
    s_cmp_ge_u32 s2, 512
    s_cbranch_scc1 K_end
    s_load_dwordx16 s[4:19], s[0:1], 0
    s_load_dwordx16 s[20:35], s[0:1], 64
    s_getpc_b64 s[36:37]
    s_and_b32 s36, s36, 0xffffff00
    s_lshr_b32 s38, s2, 3
    s_lshl_b32 s38, s38, 9
    v_lshrrev_b32_e64 v1, 6, v0
    v_lshl_add_u32 v1, v1, 7, s38
    v_min_u32 v1, CODE_BYTES-4, v1
    s_mov_b64 exec, 1
    global_load_dword v255, v1, s[36:37]
    s_mov_b64 exec, -1
    s_cmp_lt_u32 s2, 256
    s_cbranch_scc1 K_attn
K_conv:
    s_setprio 2
    s_sub_u32 s36, s2, 256
    s_and_b32 s37, s36, 7
    s_lshr_b32 s38, s36, 3
    v_lshrrev_b32 v7, 6, v0
    v_and_b32 v1, 63, v0
    v_readfirstlane_b32 s39, v7
    s_mov_b32 s68, 0
    v_lshrrev_b32 v2, 3, v1
    v_and_b32 v3, 7, v1
    s_lshl_b32 s42, s38, 16
    s_lshl_b32 s43, s39, 14
    s_add_u32 s42, s42, s43
    s_lshl_b32 s43, s37, 7
    s_add_u32 s42, s42, s43
    v_lshlrev_b32 v9, 11, v2
    v_lshl_add_u32 v9, v3, 4, v9
    v_add_u32 v252, s42, v9
    s_lshl_b32 s36, s37, 6
    s_lshl_b32 s44, s38, 1
    s_add_u32 s36, s36, s44
    s_lshl_b32 s44, s36, 1
    s_lshl_b32 s42, s36, 8
    s_lshl_b32 s40, s39, 7
    s_add_u32 s42, s42, s40
    v_lshl_add_u32 v8, v1, 1, s42
    s_add_u32 s43, s43, 7356544
    s_waitcnt lgkmcnt(0)
    s_nop 0
    s_load_dword s49, s[34:35], s43
    s_load_dword s47, s[18:19], s44
    s_load_dword s48, s[20:21], s44
    global_load_ushort v32, v8, s[6:7]
    global_load_ushort v33, v8, s[8:9]
    global_load_ushort v34, v8, s[10:11]
    global_load_ushort v35, v8, s[12:13]
    global_load_ushort v36, v8, s[14:15]
    global_load_ushort v37, v8, s[16:17]
    s_branch A_mid
K_attn:
    s_setprio 1
    s_and_b32 s36, s2, 7
    s_lshr_b32 s37, s2, 3
    v_lshrrev_b32 v2, 6, v0
    v_and_b32 v1, 63, v0
    v_readfirstlane_b32 s40, v2
    s_lshr_b32 s41, s36, 1
    s_lshl_b32 s41, s41, 2
    s_lshr_b32 s42, s37, 3
    s_add_u32 s38, s41, s42
    v_lshrrev_b32 v2, 3, v1
    v_lshrrev_b32 v3, 4, v1
    v_and_b32 v4, 7, v1
    v_xor_b32 v3, v3, v4
    v_lshlrev_b32 v3, 4, v3
    v_lshl_add_u32 v2, v2, 10, v3
    s_lshl_b32 s41, s38, 17
    s_lshl_b32 s42, s40, 15
    s_add_u32 s43, s41, s42
    s_lshl_b32 s47, s40, 12
    s_lshr_b32 s42, s37, 3
    s_lshl_b32 s3, s42, 1
    s_xor_b32 s3, s3, s37
    s_and_b32 s3, s3, 7
    s_lshl_b32 s41, s3, 7
    s_add_u32 s41, s41, s43
    v_add_u32 v6, s41, v2
    v_xor_b32 v7, 64, v6
    v_add_u32 v7, 0x2000, v7
    v_add_u32 v8, 0x4000, v6
    v_add_u32 v9, 0x4000, v7
    s_waitcnt lgkmcnt(0)
    s_add_u32 m0, s47, 32768
    s_and_b32 s42, s36, 1
    global_load_lds_dwordx4 v6, s[22:23]
    s_add_u32 m0, s47, 33792
    s_lshl_b32 s42, s42, 3
    global_load_lds_dwordx4 v7, s[22:23]
    s_add_u32 m0, s47, 34816
    s_and_b32 s50, s37, 7
    global_load_lds_dwordx4 v8, s[22:23]
    s_add_u32 m0, s47, 35840
    s_add_u32 s39, s42, s50
    global_load_lds_dwordx4 v9, s[22:23]
    s_lshl_b32 s51, s40, 10
    v_lshrrev_b32_e64 v2, 2, v1
    v_mul_u32_u24 v2, 3072, v2
    v_and_b32_e64 v29, 3, v1
    v_lshl_add_u32 v10, v29, 4, v2
    s_lshl_b32 s42, s39, 6
    v_add_u32 v10, s42, v10
    s_mul_i32 s42, s40, 49152
    s_add_u32 s42, s42, 1024
    v_add_u32 v88, s42, v10
    v_lshlrev_b32 v19, 4, v1
    s_lshl_b32 s42, s39, 10
    v_add_u32 v3, s42, v19
    s_mov_b32 s42, 7356416
    s_load_dword s46, s[34:35], s42
    s_xor_b32 s14, s3, 0
    s_mul_i32 s14, s14, 196608
    s_add_u32 m0, s51, 0
    s_add_u32 s18, s24, s14
    s_addc_u32 s19, s25, 0
    global_load_lds_dwordx4 v88, s[18:19]
    s_add_u32 m0, s51, 28672
    s_nop 0
    global_load_lds_dwordx4 v3, s[26:27]
    s_branch B_cont
A_mid:
    s_lshr_b32 s40, s39, 1
    s_and_b32 s41, s39, 1
    s_mul_i32 s54, s40, 4608
    s_add_u32 s54, s54, s68
    s_lshl_b32 s55, s40, 15
    s_add_u32 s55, s55, 9216
    s_add_u32 s55, s55, s68
    s_lshl_b32 s42, s38, 17
    s_lshl_b32 s43, s39, 15
    s_add_u32 s42, s42, s43
    s_lshl_b32 s43, s37, 7
    s_add_u32 s42, s42, s43
    v_add_u32_e64 v220, s42, v9
    v_add_u32 v221, 0x4000, v220
    s_mov_b32 s50, 0x05040100
    s_mov_b32 s51, 0x07060302
    v_lshrrev_b32 v7, 2, v2
    s_lshl_b32 s42, s39, 1
    v_add_u32 v7, s42, v7
    v_xor_b32 v7, v7, v3
    v_lshlrev_b32_e64 v7, 4, v7
    v_lshl_add_u32 v7, v3, 10, v7
    v_and_b32_e64 v9, 3, v2
    v_lshl_add_u32 v4, v9, 2, v7
    v_add_u32 v4, s68, v4
    v_xor_b32 v7, s42, v3
    v_lshlrev_b32_e64 v7, 4, v7
    v_lshl_add_u32 v7, v2, 7, v7
    s_lshl_b32 s43, s39, 11
    s_add_u32 s43, s43, s68
    v_add_u32 v5, s43, v7
    v_xor_b32 v6, 16, v5
    v_add_u32 v6, 1024, v6
    s_lshl_b32 s42, s37, 18
    s_lshl_b32 s43, s39, 16
    s_add_u32 s42, s42, s43
    s_lshl_b32 s43, s38, 7
    s_add_u32 s42, s42, s43
    v_lshlrev_b32 v7, 4, v3
    v_add_u32_e64 v7, s42, v7
    v_lshl_add_u32 v200, v2, 12, v7
    v_add_u32 v201, 0x8000, v200
    v_lshl_add_u32 v218, v2, 13, v7
    v_add_u32 v219, 0x1000, v218
    s_lshl_b32 s42, s36, 12
    s_lshl_b32 s43, s39, 11
    s_add_u32 s43, s42, s43
    v_lshl_add_u32 v204, v1, 4, s43
    s_lshl_b32 s42, s37, 14
    s_lshr_b32 s43, s38, 4
    s_lshl_b32 s43, s43, 12
    s_add_u32 s42, s42, s43
    s_lshl_b32 s43, s39, 10
    s_add_u32 s42, s42, s43
    s_add_u32 s42, s42, 7405632
    v_and_b32 v7, 1, v2
    v_lshlrev_b32_e64 v7, 13, v7
    v_lshl_add_u32 v7, v3, 7, v7
    v_add_u32 v205, s42, v7
    v_mov_b32 v236, -1
    v_mov_b32 v237, -1
    v_mov_b32 v238, -1
    v_mov_b32 v239, -1
    s_lshl_b32 s42, s37, 14
    s_add_u32 s42, s42, 7405568
    s_lshl_b32 s43, s39, 12
    s_lshl_b32 s44, s38, 7
    s_add_u32 s43, s43, s44
    s_add_u32 s43, s43, s42
    v_mov_b32 v202, s43
    s_lshr_b32 s43, s38, 3
    s_lshl_b32 s43, s43, 12
    s_add_u32 s42, s42, s43
    s_lshl_b32 s43, s39, 10
    s_add_u32 s42, s42, s43
    v_lshl_add_u32 v203, v3, 7, s42
    s_lshl_b32 s42, s41, 13
    s_add_u32 s42, s42, s55
    v_lshlrev_b32_e64 v7, 4, v3
    v_lshl_add_u32 v7, v1, 7, v7
    v_add_u32 v226, s42, v7
    v_xor_b32 v227, 16, v226
    v_xor_b32 v228, 32, v226
    v_xor_b32 v229, 48, v226
    v_xor_b32_e64 v230, 64, v226
    v_xor_b32 v231, 80, v226
    v_xor_b32 v232, 96, v226
    v_xor_b32 v233, 112, v226
    v_mov_b32 v240, 0
    v_mov_b32 v241, 0
    v_mov_b32 v242, 0
    v_mov_b32_e64 v243, 0
    s_waitcnt lgkmcnt(0)
    s_mul_i32 s45, s49, 2654435761
    s_add_u32 s45, s45, 2135587861
    v_mov_b32 v10, s45
    s_mov_b32 s46, 0
    s_getreg_b32 s42, hwreg(HW_REG_XCC_ID, 0, 4)
    s_and_b32 s43, s45, -16
    s_or_b32 s43, s43, s42
    v_mov_b32_e64 v234, s43
    s_lshl_b32 s42, s39, 2
    s_add_u32 s42, s42, 74752
    s_add_u32 s42, s42, s68
    v_mov_b32_e64 v235, s42
    s_branch A_cont
B_cont:
    s_add_u32 m0, s47, 49152
    v_xor_b32 v6, 128, v6
    global_load_lds_dwordx4 v6, s[22:23]
    s_add_u32 m0, s47, 50176
    v_xor_b32 v7, 128, v7
    global_load_lds_dwordx4 v7, s[22:23]
    s_add_u32 m0, s47, 51200
    v_xor_b32 v8, 128, v8
    global_load_lds_dwordx4 v8, s[22:23]
    s_add_u32 m0, s47, 52224
    v_xor_b32 v9, 128, v9
    global_load_lds_dwordx4 v9, s[22:23]
    s_add_u32 m0, s47, 65536
    v_xor_b32 v6, 384, v6
    global_load_lds_dwordx4 v6, s[22:23]
    s_add_u32 m0, s47, 66560
    v_xor_b32 v7, 384, v7
    global_load_lds_dwordx4 v7, s[22:23]
    s_add_u32 m0, s47, 67584
    v_xor_b32 v8, 384, v8
    global_load_lds_dwordx4 v8, s[22:23]
    s_add_u32 m0, s47, 68608
    v_xor_b32 v9, 384, v9
    global_load_lds_dwordx4 v9, s[22:23]
    s_xor_b32 s14, s3, 1
    s_mul_i32 s14, s14, 196608
    s_add_u32 m0, s51, 4096
    s_add_u32 s18, s24, s14
    s_addc_u32 s19, s25, 0
    global_load_lds_dwordx4 v88, s[18:19]
    s_lshl_b32 s42, s39, 11
    s_add_u32 s41, s43, s42
    s_add_u32 s41, s41, 4194304
    s_add_u32 s76, s34, s41
    s_addc_u32 s77, s35, 0
    s_lshl_b32 s41, s39, 4
    s_add_u32 s41, s41, s38
    s_mul_i32 s41, s41, 3072
    s_add_u32 s41, s41, 6291456
    s_add_u32 s4, s34, s41
    s_addc_u32 s5, s35, 0
    v_mul_u32_u24 v20, 12, v0
    v_and_b32 v26, 31, v1
    v_lshrrev_b32 v27, 5, v1
    v_bfe_u32 v28, v1, 2, 2
    v_bfe_u32 v30, v1, 4, 1
    v_lshrrev_b32 v48, 1, v29
    v_lshlrev_b32 v31, 9, v27
    v_lshl_add_u32 v31, v28, 5, v31
    v_lshl_add_u32 v31, v30, 4, v31
    v_lshl_add_u32 v31, v48, 3, v31
    v_add_u32_e64 v31, s51, v31
    v_bfe_u32 v48, v1, 1, 3
    v_xor_b32 v48, v48, v27
    v_lshlrev_b32 v48, 4, v48
    v_lshl_add_u32 v48, v26, 7, v48
    s_add_u32 s41, s47, 32768
    v_add_u32 v12, s41, v48
    v_xor_b32 v13, 32, v12
    v_xor_b32_e64 v14, 64, v12
    v_xor_b32 v15, 96, v12
    v_bfe_u32 v48, v1, 2, 1
    v_cmp_eq_u32 s[52:53], v48, v27
    v_cmp_eq_u32 s[54:55], 1, v30
    s_mov_b32 s45, 0
    s_mov_b32 s48, 0x3fb8aa3b
    v_add_u32 v11, 49152, v10
    v_add_u32 v21, 98304, v10
    v_add_u32 v108, 147456, v10
    s_xor_b32 s42, s40, s3
    s_xor_b32 s14, s3, 2
    s_mul_i32 s14, s14, 196608
    s_add_u32 m0, s51, 8192
    s_add_u32 s18, s24, s14
    s_addc_u32 s19, s25, 0
    global_load_lds_dwordx4 v88, s[18:19]
    s_mul_i32 s41, s42, 196608
    s_add_u32 s10, s24, s41
    s_addc_u32 s11, s25, 0
    s_xor_b32 s42, s42, 4
    s_mul_i32 s41, s42, 196608
    s_add_u32 s12, s24, s41
    s_addc_u32 s13, s25, 0
    s_lshr_b32 s42, s37, 3
    s_add_u32 s33, s42, s37
    v_lshl_add_u32 v48, v27, 3, v28
    v_lshlrev_b32 v48, 6, v48
    v_lshlrev_b32 v49, 3, v29
    v_lshl_add_u32 v49, v30, 5, v49
    v_add_u32_e64 v49, v48, v49
    v_add_u32 v18, 32768, v49
    v_and_b32_e64 v49, 1, v29
    v_lshl_add_u32 v48, v49, 5, v48
    v_lshl_add_u32 v48, v30, 4, v48
    v_lshrrev_b32_e64 v49, 1, v29
    v_lshl_add_u32 v16, v49, 3, v48
    v_add_u32 v17, 32768, v16
    v_bfe_u32 v48, v1, 2, 1
    v_bfe_u32 v49, v1, 3, 1
    v_lshl_add_u32 v50, v49, 2, v29
    v_and_b32 v51, 1, v50
    v_lshlrev_b32 v51, 4, v51
    v_mov_b32 v52, 0x3f80
    v_lshlrev_b32 v51, v51, v52
    v_cmp_eq_u32 vcc, v30, v27
    s_nop 1
    v_cndmask_b32 v51, 0, v51, vcc
    v_lshrrev_b32_e64 v52, 1, v50
    v_lshl_add_u32 v52, v48, 2, v52
    v_cmp_eq_u32 vcc, 0, v52
    s_nop 1
    v_cndmask_b32 v112, 0, v51, vcc
    v_cmp_eq_u32 vcc, 1, v52
    s_nop 1
    v_cndmask_b32 v113, 0, v51, vcc
    v_cmp_eq_u32 vcc, 2, v52
    s_nop 1
    v_cndmask_b32 v114, 0, v51, vcc
    v_cmp_eq_u32 vcc, 3, v52
    s_nop 1
    v_cndmask_b32_e64 v115, 0, v51, vcc
    s_xor_b32 s14, s3, 3
    s_mul_i32 s14, s14, 196608
    s_add_u32 m0, s51, 12288
    s_add_u32 s18, s24, s14
    s_addc_u32 s19, s25, 0
    global_load_lds_dwordx4 v88, s[18:19]
    v_cmp_eq_u32 vcc, 4, v52
    s_nop 1
    v_cndmask_b32 v116, 0, v51, vcc
    v_cmp_eq_u32 vcc, 5, v52
    s_nop 1
    v_cndmask_b32 v117, 0, v51, vcc
    v_cmp_eq_u32 vcc, 6, v52
    s_nop 1
    v_cndmask_b32 v118, 0, v51, vcc
    v_cmp_eq_u32 vcc, 7, v52
    s_nop 1
    v_cndmask_b32 v119, 0, v51, vcc
    v_lshl_add_u32 v50, v48, 3, v50
    v_lshl_add_u32 v50, v27, 4, v50
    v_lshl_add_u32 v50, v30, 5, v50
    v_lshlrev_b32_e64 v50, 1, v50
    v_add_u32 v99, 18944, v50
    s_add_u32 s41, s47, 16384
    v_add_u32_e64 v96, s41, v19
    s_add_u32 s41, s51, 16384
    v_add_u32 v111, s41, v19
    v_lshlrev_b32 v48, 2, v1
    v_add_u32 v97, 16384, v48
    v_mul_u32_u24 v48, 80, v26
    v_lshl_add_u32 v48, v27, 4, v48
    s_lshr_b32 s41, s40, 1
    s_lshl_b32 s41, s41, 5
    s_and_b32 s42, s40, 1
    s_lshl_b32 s42, s42, 3
    s_add_u32 s41, s41, s42
    s_add_u32 s41, s41, 16384
    v_add_u32 v98, s41, v48
    v_bfe_u32 v48, v1, 3, 2
    v_lshl_add_u32 v48, v48, 2, v29
    v_lshl_add_u32 v48, v27, 4, v48
    v_mul_u32_u24 v48, 80, v48
    v_add_u32 v48, 16384, v48
    v_mov_b32 v49, 19072
    v_cndmask_b32 v100, v49, v48, s[52:53]
    v_lshlrev_b32_e64 v48, 6, v27
    v_add_u32 v48, 18944, v48
    v_lshrrev_b32 v50, 4, v1
    v_lshlrev_b32 v50, 2, v50
    v_and_b32 v51, 15, v1
    s_xor_b32 s14, s3, 4
    s_mul_i32 s14, s14, 196608
    s_add_u32 m0, s51, 16384
    s_add_u32 s18, s24, s14
    s_addc_u32 s19, s25, 0
    global_load_lds_dwordx4 v88, s[18:19]
    v_sub_u32 v50, v51, v50
    v_cmp_eq_u32 vcc, 0, v50
    s_nop 1
    v_cndmask_b32 v101, v49, v48, vcc
    v_add_u32 v49, 64, v49
    v_cmp_eq_u32 vcc, 1, v50
    s_nop 1
    v_cndmask_b32 v101, v101, v49, vcc
    s_mul_i32 s41, s39, 49152
    s_add_u32 s41, s41, 6294528
    s_add_u32 s42, s38, 0
    s_and_b32 s42, s42, 3
    s_mul_i32 s42, s42, 12288
    s_add_u32 s42, s42, s41
    s_add_u32 s56, s34, s42
    s_addc_u32 s57, s35, 0
    s_add_u32 s42, s38, 1
    s_and_b32 s42, s42, 3
    s_mul_i32 s42, s42, 12288
    s_add_u32 s42, s42, s41
    s_add_u32 s58, s34, s42
    s_addc_u32 s59, s35, 0
    s_add_u32 s42, s38, 2
    s_and_b32 s42, s42, 3
    s_mul_i32 s42, s42, 12288
    s_add_u32 s42, s42, s41
    s_add_u32 s60, s34, s42
    s_addc_u32 s61, s35, 0
    s_add_u32 s42, s38, 3
    s_and_b32 s42, s42, 3
    s_mul_i32 s42, s42, 12288
    s_add_u32 s42, s42, s41
    s_add_u32 s62, s34, s42
    s_addc_u32 s63, s35, 0
    s_and_b32 s50, s37, 7
    s_lshl_b32 s49, s36, 2
    s_lshr_b32 s41, s37, 3
    s_add_u32 s49, s49, s41
    v_lshrrev_b32 v48, 3, v1
    v_and_b32 v49, 7, v1
    v_lshlrev_b32 v50, 1, v30
    v_xor_b32_e64 v50, v50, v49
    s_xor_b32 s14, s3, 5
    s_mul_i32 s14, s14, 196608
    s_add_u32 m0, s51, 20480
    s_add_u32 s18, s24, s14
    s_addc_u32 s19, s25, 0
    global_load_lds_dwordx4 v88, s[18:19]
    v_lshlrev_b32_e64 v50, 4, v50
    v_lshl_add_u32 v107, v48, 10, v50
    s_lshl_b32 s41, s50, 7
    s_lshl_b32 s42, s40, 15
    s_add_u32 s43, s41, s42
    s_add_u32 s78, s28, s43
    s_addc_u32 s79, s29, 0
    v_lshlrev_b32 v50, 4, v49
    v_lshl_add_u32 v106, v48, 11, v50
    s_lshl_b32 s41, s49, 17
    s_add_u32 s41, s41, s43
    s_add_u32 s41, s41, 1024
    s_add_u32 s6, s30, s41
    s_addc_u32 s7, s31, 0
    s_add_u32 s8, s6, 0x4000
    s_addc_u32 s9, s7, 0
    s_mul_i32 s41, s40, 2304
    s_add_u32 s41, s41, 20480
    v_mul_u32_u24 v48, 144, v48
    v_add3_u32 v105, v48, v50, s41
    v_and_b32 v49, 15, v1
    v_lshrrev_b32_e64 v50, 4, v1
    v_mul_u32_u24 v48, 144, v49
    v_lshl_add_u32 v48, v50, 3, v48
    v_add_u32_e64 v104, s41, v48
    v_lshl_add_u32 v48, v50, 3, v28
    v_lshlrev_b32_e64 v48, 7, v48
    v_lshl_add_u32 v48, v29, 3, v48
    v_lshrrev_b32_e64 v50, 1, v28
    v_lshl_add_u32 v50, v30, 1, v50
    v_lshl_add_u32 v102, v50, 5, v48
    v_lshlrev_b32_e64 v48, 4, v49
    v_lshl_add_u32 v48, v30, 10, v48
    v_lshl_add_u32 v103, v27, 9, v48
    s_lshl_b32 s41, s49, 16
    s_lshr_b32 s42, s40, 1
    s_lshl_b32 s42, s42, 15
    s_add_u32 s41, s41, s42
    s_and_b32 s42, s40, 1
    s_lshl_b32 s42, s42, 8
    s_xor_b32 s14, s3, 6
    s_mul_i32 s14, s14, 196608
    s_add_u32 m0, s51, 24576
    s_add_u32 s18, s24, s14
    s_addc_u32 s19, s25, 0
    global_load_lds_dwordx4 v88, s[18:19]
    s_add_u32 s41, s41, s42
    s_add_u32 s41, s41, 4198400
    s_add_u32 s42, s33, 0
    s_and_b32 s42, s42, 3
    s_lshl_b32 s42, s42, 13
    s_add_u32 s42, s42, s41
    s_add_u32 s68, s34, s42
    s_addc_u32 s69, s35, 0
    s_add_u32 s42, s33, 1
    s_and_b32 s42, s42, 3
    s_lshl_b32 s42, s42, 13
    s_add_u32 s42, s42, s41
    s_add_u32 s70, s34, s42
    s_addc_u32 s71, s35, 0
    s_add_u32 s42, s33, 2
    s_and_b32 s42, s42, 3
    s_lshl_b32 s42, s42, 13
    s_add_u32 s42, s42, s41
    s_add_u32 s72, s34, s42
    s_addc_u32 s73, s35, 0
    s_add_u32 s42, s33, 3
    s_and_b32 s42, s42, 3
    s_lshl_b32 s42, s42, 13
    s_add_u32 s42, s42, s41
    s_add_u32 s74, s34, s42
    s_addc_u32 s75, s35, 0
    s_lshr_b32 s41, s49, 1
    s_lshl_b32 s41, s41, 11
    s_lshl_b32 s42, s40, 9
    s_add_u32 s41, s41, s42
    s_add_u32 s41, s41, 7372800
    v_lshl_add_u32 v109, v29, 7, s41
    s_lshl_b32 s41, s38, 4
    s_add_u32 s41, s41, s39
    s_lshl_b32 s41, s41, 7
    s_add_u32 s41, s41, 7372800
    v_mov_b32_e64 v110, s41
    s_waitcnt vmcnt(14)
    ds_read_b128 v[128:131], v12 offset:0
    ds_read_b128 v[132:135], v13 offset:0
    ds_read_b128 v[136:139], v14 offset:0
    ds_read_b128 v[140:143], v15 offset:0
    ds_read_b64_tr_b16 v[120:121], v31 offset:28672
    ds_read_b64_tr_b16 v[122:123], v31 offset:28800
    ds_read_b64_tr_b16 v[124:125], v31 offset:28928
    ds_read_b64_tr_b16 v[126:127], v31 offset:29056
    s_waitcnt lgkmcnt(0)
    s_xor_b32 s14, s3, 7
    s_mul_i32 s14, s14, 196608
    s_add_u32 m0, s51, 28672
    s_add_u32 s18, s24, s14
    s_addc_u32 s19, s25, 0
    global_load_lds_dwordx4 v88, s[18:19]
    s_mul_i32 s44, s46, 2654435761
    s_add_u32 s44, s44, 2135587861
    s_and_b32 s44, s44, 0xffffbfff
    v_mov_b32_e64 v5, s44
    s_add_u32 m0, s47, 32768
    v_xor_b32 v6, 128, v6
    v_cndmask_b32 v120, 0, v120, s[52:53]
    global_load_lds_dwordx4 v6, s[22:23]
    v_cndmask_b32 v121, 0, v121, s[52:53]
    s_add_u32 m0, s47, 33792
    v_xor_b32 v7, 128, v7
    v_cndmask_b32 v122, 0, v122, s[52:53]
    global_load_lds_dwordx4 v7, s[22:23]
    v_cndmask_b32 v123, 0, v123, s[52:53]
    s_add_u32 m0, s47, 34816
    v_xor_b32 v8, 128, v8
    v_cndmask_b32 v124, 0, v124, s[52:53]
    global_load_lds_dwordx4 v8, s[22:23]
    v_cndmask_b32 v125, 0, v125, s[52:53]
    s_add_u32 m0, s47, 35840
    v_xor_b32 v9, 128, v9
    v_cndmask_b32 v126, 0, v126, s[52:53]
    global_load_lds_dwordx4 v9, s[22:23]
    v_cndmask_b32 v127, 0, v127, s[52:53]
    s_waitcnt vmcnt(15)
    ds_read_b128 v[144:147], v12 offset:16384
    ds_read_b128 v[148:151], v13 offset:16384
    ds_read_b128 v[152:155], v14 offset:16384
    ds_read_b128 v[156:159], v15 offset:16384
    s_waitcnt lgkmcnt(0)
    s_add_u32 m0, s47, 49152
    v_xor_b32 v6, 896, v6
    global_load_lds_dwordx4 v6, s[22:23]
    s_add_u32 m0, s47, 50176
    v_xor_b32 v7, 896, v7
    global_load_lds_dwordx4 v7, s[22:23]
    s_add_u32 m0, s47, 51200
    v_xor_b32 v8, 896, v8
    global_load_lds_dwordx4 v8, s[22:23]
    s_add_u32 m0, s47, 52224
    v_xor_b32 v9, 896, v9
    global_load_lds_dwordx4 v9, s[22:23]
    s_waitcnt vmcnt(15)
    ds_read_b128 v[160:163], v12 offset:32768
    ds_read_b128 v[164:167], v13 offset:32768
    ds_read_b128 v[168:171], v14 offset:32768
    ds_read_b128 v[172:175], v15 offset:32768
    s_waitcnt lgkmcnt(0)
    s_add_u32 m0, s47, 65536
    v_xor_b32 v6, 128, v6
    global_load_lds_dwordx4 v6, s[22:23]
    s_add_u32 m0, s47, 66560
    v_xor_b32 v7, 128, v7
    global_load_lds_dwordx4 v7, s[22:23]
    s_add_u32 m0, s47, 67584
    v_xor_b32 v8, 128, v8
    global_load_lds_dwordx4 v8, s[22:23]
    s_add_u32 m0, s47, 68608
    v_xor_b32 v9, 128, v9
    global_load_lds_dwordx4 v9, s[22:23]
    s_waitcnt vmcnt(8)
    ds_read_b128 v[176:179], v12 offset:0
    ds_read_b128 v[180:183], v13 offset:0
    ds_read_b128 v[184:187], v14 offset:0
    ds_read_b128 v[188:191], v15 offset:0
    s_barrier
    ds_read_b64_tr_b16 v[48:49], v16 offset:0
    ds_read_b64_tr_b16 v[50:51], v16 offset:256
    ds_read_b64_tr_b16 v[52:53], v16 offset:1024
    ds_read_b64_tr_b16 v[54:55], v16 offset:1280
    ds_read_b64_tr_b16 v[56:57], v16 offset:2048
    ds_read_b64_tr_b16 v[58:59], v16 offset:2304
    ds_read_b64_tr_b16 v[60:61], v16 offset:3072
    ds_read_b64_tr_b16 v[62:63], v16 offset:3328
    ds_read_b64_tr_b16 v[64:65], v16 offset:4096
    ds_read_b64_tr_b16 v[66:67], v16 offset:4352
    ds_read_b64_tr_b16 v[68:69], v16 offset:5120
    ds_read_b64_tr_b16 v[70:71], v16 offset:5376
    ds_read_b64_tr_b16 v[72:73], v16 offset:6144
    ds_read_b64_tr_b16 v[74:75], v16 offset:6400
    s_waitcnt lgkmcnt(14)
    s_add_u32 m0, s47, 32768
    v_xor_b32 v6, 384, v6
    s_waitcnt lgkmcnt(12)
    v_mfma_f32_32x32x16_bf16 v[32:47], v[48:51], v[128:131], 0
    global_load_lds_dwordx4 v6, s[22:23]
    ds_read_b64_tr_b16 v[76:77], v16 offset:7168
    ds_read_b64_tr_b16 v[78:79], v16 offset:7424
    s_waitcnt lgkmcnt(12)
    v_mfma_f32_32x32x16_bf16 v[32:47], v[52:55], v[132:135], v[32:47]
    ds_read_b64_tr_b16 v[48:49], v16 offset:8192
    ds_read_b64_tr_b16 v[50:51], v16 offset:8448
    s_add_u32 m0, s47, 33792
    v_xor_b32 v7, 384, v7
    s_waitcnt lgkmcnt(12)
    v_mfma_f32_32x32x16_bf16 v[32:47], v[56:59], v[136:139], v[32:47]
    global_load_lds_dwordx4 v7, s[22:23]
    ds_read_b64_tr_b16 v[52:53], v16 offset:9216
    ds_read_b64_tr_b16 v[54:55], v16 offset:9472
    s_waitcnt lgkmcnt(12)
    v_mfma_f32_32x32x16_bf16 v[32:47], v[60:63], v[140:143], v[32:47]
    ds_read_b64_tr_b16 v[56:57], v16 offset:10240
    ds_read_b64_tr_b16 v[58:59], v16 offset:10496
    s_add_u32 m0, s47, 34816
    v_xor_b32 v8, 384, v8
    s_waitcnt lgkmcnt(12)
    v_mfma_f32_32x32x16_bf16 v[32:47], v[64:67], v[144:147], v[32:47]
    global_load_lds_dwordx4 v8, s[22:23]
    ds_read_b64_tr_b16 v[60:61], v16 offset:11264
    ds_read_b64_tr_b16 v[62:63], v16 offset:11520
    s_waitcnt lgkmcnt(12)
    v_mfma_f32_32x32x16_bf16 v[32:47], v[68:71], v[148:151], v[32:47]
    ds_read_b64_tr_b16 v[64:65], v16 offset:12288
    ds_read_b64_tr_b16 v[66:67], v16 offset:12544
    s_add_u32 m0, s47, 35840
    v_xor_b32 v9, 384, v9
    s_waitcnt lgkmcnt(12)
    v_mfma_f32_32x32x16_bf16 v[32:47], v[72:75], v[152:155], v[32:47]
    global_load_lds_dwordx4 v9, s[22:23]
    ds_read_b64_tr_b16 v[68:69], v16 offset:13312
    ds_read_b64_tr_b16 v[70:71], v16 offset:13568
    s_waitcnt lgkmcnt(12)
    v_mfma_f32_32x32x16_bf16 v[32:47], v[76:79], v[156:159], v[32:47]
    ds_read_b64_tr_b16 v[72:73], v16 offset:14336
    ds_read_b64_tr_b16 v[74:75], v16 offset:14592
    s_waitcnt vmcnt(8)
    ds_read_b128 v[192:195], v12 offset:16384
    ds_read_b128 v[196:199], v13 offset:16384
    ds_read_b128 v[200:203], v14 offset:16384
    ds_read_b128 v[204:207], v15 offset:16384
    s_waitcnt lgkmcnt(0)
    s_nop 0
    s_add_u32 m0, s47, 49152
    v_xor_b32 v6, 128, v6
    v_mfma_f32_32x32x16_bf16 v[32:47], v[48:51], v[160:163], v[32:47]
    global_load_lds_dwordx4 v6, s[22:23]
    ds_read_b64_tr_b16 v[76:77], v16 offset:15360
    ds_read_b64_tr_b16 v[78:79], v16 offset:15616
    v_mfma_f32_32x32x16_bf16 v[32:47], v[52:55], v[164:167], v[32:47]
    ds_read_b64_tr_b16 v[48:49], v16 offset:16384
    ds_read_b64_tr_b16 v[50:51], v16 offset:16640
    s_add_u32 m0, s47, 50176
    v_xor_b32 v7, 128, v7
    v_mfma_f32_32x32x16_bf16 v[32:47], v[56:59], v[168:171], v[32:47]
    global_load_lds_dwordx4 v7, s[22:23]
    ds_read_b64_tr_b16 v[52:53], v16 offset:17408
    ds_read_b64_tr_b16 v[54:55], v16 offset:17664
    v_mfma_f32_32x32x16_bf16 v[32:47], v[60:63], v[172:175], v[32:47]
    ds_read_b64_tr_b16 v[56:57], v16 offset:18432
    ds_read_b64_tr_b16 v[58:59], v16 offset:18688
    s_add_u32 m0, s47, 51200
    v_xor_b32 v8, 128, v8
    v_mfma_f32_32x32x16_bf16 v[32:47], v[64:67], v[176:179], v[32:47]
    global_load_lds_dwordx4 v8, s[22:23]
    ds_read_b64_tr_b16 v[60:61], v16 offset:19456
    ds_read_b64_tr_b16 v[62:63], v16 offset:19712
    v_mfma_f32_32x32x16_bf16 v[32:47], v[68:71], v[180:183], v[32:47]
    ds_read_b64_tr_b16 v[64:65], v16 offset:20480
    ds_read_b64_tr_b16 v[66:67], v16 offset:20736
    s_add_u32 m0, s47, 52224
    v_xor_b32 v9, 128, v9
    v_mfma_f32_32x32x16_bf16 v[32:47], v[72:75], v[184:187], v[32:47]
    global_load_lds_dwordx4 v9, s[22:23]
    ds_read_b64_tr_b16 v[68:69], v16 offset:21504
    ds_read_b64_tr_b16 v[70:71], v16 offset:21760
    s_waitcnt lgkmcnt(12)
    v_mfma_f32_32x32x16_bf16 v[32:47], v[76:79], v[188:191], v[32:47]
    ds_read_b64_tr_b16 v[72:73], v16 offset:22528
    ds_read_b64_tr_b16 v[74:75], v16 offset:22784
    s_waitcnt vmcnt(8)
    ds_read_b128 v[208:211], v12 offset:32768
    ds_read_b128 v[212:215], v13 offset:32768
    ds_read_b128 v[216:219], v14 offset:32768
    ds_read_b128 v[220:223], v15 offset:32768
    s_waitcnt lgkmcnt(0)
    s_nop 0
    s_add_u32 m0, s47, 63488
    v_mfma_f32_32x32x16_bf16 v[32:47], v[48:51], v[192:195], v[32:47]
    global_load_lds_dwordx4 v10, s[10:11] offset:2048
    ds_read_b64_tr_b16 v[76:77], v16 offset:23552
    ds_read_b64_tr_b16 v[78:79], v16 offset:23808
    v_mfma_f32_32x32x16_bf16 v[32:47], v[52:55], v[196:199], v[32:47]
    ds_read_b64_tr_b16 v[48:49], v16 offset:24576
    ds_read_b64_tr_b16 v[50:51], v16 offset:24832
    s_add_u32 m0, s47, 64512
    v_mfma_f32_32x32x16_bf16 v[32:47], v[56:59], v[200:203], v[32:47]
    global_load_lds_dwordx4 v11, s[10:11] offset:2048
    ds_read_b64_tr_b16 v[52:53], v16 offset:25600
    ds_read_b64_tr_b16 v[54:55], v16 offset:25856
    v_mfma_f32_32x32x16_bf16 v[32:47], v[60:63], v[204:207], v[32:47]
    ds_read_b64_tr_b16 v[56:57], v16 offset:26624
    ds_read_b64_tr_b16 v[58:59], v16 offset:26880
    s_add_u32 m0, s47, 65536
    v_mfma_f32_32x32x16_bf16 v[32:47], v[64:67], v[208:211], v[32:47]
    global_load_lds_dwordx4 v21, s[10:11] offset:2048
    ds_read_b64_tr_b16 v[60:61], v16 offset:27648
    ds_read_b64_tr_b16 v[62:63], v16 offset:27904
    v_mfma_f32_32x32x16_bf16 v[32:47], v[68:71], v[212:215], v[32:47]
    ds_read_b64_tr_b16 v[64:65], v16 offset:28672
    ds_read_b64_tr_b16 v[66:67], v16 offset:28928
    s_add_u32 m0, s47, 66560
    v_mfma_f32_32x32x16_bf16 v[32:47], v[72:75], v[216:219], v[32:47]
    global_load_lds_dwordx4 v108, s[10:11] offset:2048
    ds_read_b64_tr_b16 v[68:69], v16 offset:29696
    ds_read_b64_tr_b16 v[70:71], v16 offset:29952
    s_waitcnt lgkmcnt(12)
    v_mfma_f32_32x32x16_bf16 v[32:47], v[76:79], v[220:223], v[32:47]
    ds_read_b64_tr_b16 v[72:73], v16 offset:30720
    ds_read_b64_tr_b16 v[74:75], v16 offset:30976
    s_waitcnt vmcnt(8)
    ds_read_b128 v[224:227], v12 offset:0
    ds_read_b128 v[228:231], v13 offset:0
    ds_read_b128 v[232:235], v14 offset:0
    ds_read_b128 v[236:239], v15 offset:0
    s_waitcnt lgkmcnt(0)
    s_nop 0
    s_add_u32 m0, s47, 30720
    v_mfma_f32_32x32x16_bf16 v[32:47], v[48:51], v[224:227], v[32:47]
    global_load_lds_dwordx4 v10, s[12:13] offset:2048
    ds_read_b64_tr_b16 v[76:77], v16 offset:31744
    ds_read_b64_tr_b16 v[78:79], v16 offset:32000
    v_mfma_f32_32x32x16_bf16 v[32:47], v[52:55], v[228:231], v[32:47]
    s_add_u32 m0, s47, 31744
    v_mfma_f32_32x32x16_bf16 v[32:47], v[56:59], v[232:235], v[32:47]
    global_load_lds_dwordx4 v11, s[12:13] offset:2048
    v_mfma_f32_32x32x16_bf16 v[32:47], v[60:63], v[236:239], v[32:47]
    s_waitcnt vmcnt(6)
    ds_read_b128 v[240:243], v12 offset:16384
    ds_read_b128 v[244:247], v13 offset:16384
    ds_read_b128 v[248:251], v14 offset:16384
    ds_read_b128 v[252:255], v15 offset:16384
    s_waitcnt lgkmcnt(0)
    s_add_u32 m0, s47, 32768
    v_mfma_f32_32x32x16_bf16 v[32:47], v[64:67], v[240:243], v[32:47]
    global_load_lds_dwordx4 v21, s[12:13] offset:2048
    v_mfma_f32_32x32x16_bf16 v[32:47], v[68:71], v[244:247], v[32:47]
    s_add_u32 m0, s47, 33792
    v_mfma_f32_32x32x16_bf16 v[32:47], v[72:75], v[248:251], v[32:47]
    global_load_lds_dwordx4 v108, s[12:13] offset:2048
    v_mfma_f32_32x32x16_bf16 v[32:47], v[76:79], v[252:255], v[32:47]
    s_nop 11
    s_nop 0
    v_cvt_pk_bf16_f32 v80, v32, v33
    v_cvt_pk_bf16_f32 v81, v34, v35
    v_cvt_pk_bf16_f32 v82, v36, v37
    v_cvt_pk_bf16_f32 v83, v38, v39
    v_cvt_pk_bf16_f32 v84, v40, v41
    v_cvt_pk_bf16_f32 v85, v42, v43
    v_cvt_pk_bf16_f32 v86, v44, v45
    v_cvt_pk_bf16_f32 v87, v46, v47
    v_mfma_f32_32x32x16_bf16 v[32:47], v[120:123], v[80:83], 0
    s_nop 0
    v_mfma_f32_32x32x16_bf16 v[32:47], v[124:127], v[84:87], v[32:47]
    v_mov_b32 v12, -1
    v_mov_b32 v13, -1
    v_mov_b32 v14, -1
    v_mov_b32 v15, -1
    s_nop 7
    v_max3_f32 v22, v32, v33, v34
    v_min3_f32 v23, v32, v33, v34
    v_max3_f32 v22, v22, v35, v36
    v_min3_f32 v23, v23, v35, v36
    v_max3_f32 v22, v22, v37, v38
    v_min3_f32 v23, v23, v37, v38
    v_max3_f32 v22, v22, v39, v40
    v_min3_f32 v23, v23, v39, v40
    v_max3_f32 v22, v22, v41, v42
    v_min3_f32 v23, v23, v41, v42
    v_max3_f32 v22, v22, v43, v44
    v_min3_f32 v23, v23, v43, v44
    v_max3_f32 v22, v22, v45, v46
    v_min3_f32 v23, v23, v45, v46
    v_max_f32 v22, v22, v47
    v_min_f32 v23, v23, v47
    v_mul_f32 v22, s48, v22
    v_mul_f32 v23, s48, v23
    v_fma_f32 v80, v32, s48, -v22
    v_fma_f32 v32, -v32, s48, v23
    v_exp_f32 v80, v80
    v_exp_f32 v32, v32
    v_fma_f32 v81, v33, s48, -v22
    v_fma_f32 v33, -v33, s48, v23
    v_exp_f32 v81, v81
    v_exp_f32 v33, v33
    v_fma_f32 v82, v34, s48, -v22
    v_fma_f32 v34, -v34, s48, v23
    v_exp_f32 v82, v82
    v_exp_f32 v34, v34
    v_add_f32 v24, v80, v81
    v_add_f32 v25, v32, v33
    v_fma_f32 v83, v35, s48, -v22
    v_fma_f32 v35, -v35, s48, v23
    v_exp_f32 v83, v83
    v_exp_f32 v35, v35
    v_add_f32 v24, v24, v82
    v_add_f32 v25, v25, v34
    v_fma_f32 v84, v36, s48, -v22
    v_fma_f32 v36, -v36, s48, v23
    s_waitcnt vmcnt(4)
    s_barrier
    ds_read_b64_tr_b16 v[64:65], v18 offset:32768
    ds_read_b64_tr_b16 v[66:67], v18 offset:33024
    ds_read_b64_tr_b16 v[68:69], v18 offset:33792
    ds_read_b64_tr_b16 v[70:71], v18 offset:34048
    ds_read_b64_tr_b16 v[72:73], v18 offset:34816
    ds_read_b64_tr_b16 v[74:75], v18 offset:35072
    v_exp_f32 v84, v84
    v_exp_f32 v36, v36
    v_add_f32 v24, v24, v83
    v_add_f32_e64 v25, v25, v35
    s_waitcnt lgkmcnt(2)
    v_mfma_f32_32x32x16_bf16 v[48:63], v[128:131], v[64:67], 0
    ds_read_b64_tr_b16 v[76:77], v18 offset:35840
    ds_read_b64_tr_b16 v[78:79], v18 offset:36096
    v_fma_f32 v85, v37, s48, -v22
    v_fma_f32 v37, -v37, s48, v23
    v_exp_f32 v85, v85
    v_exp_f32 v37, v37
    global_store_dwordx4 v19, v[12:15], s[76:77] offset:0 sc1
    v_mfma_f32_32x32x16_bf16 v[48:63], v[132:135], v[68:71], v[48:63]
    ds_read_b64_tr_b16 v[64:65], v18 offset:36864
    ds_read_b64_tr_b16 v[66:67], v18 offset:37120
    v_add_f32 v24, v24, v84
    v_add_f32 v25, v25, v36
    v_fma_f32 v86, v38, s48, -v22
    v_fma_f32 v38, -v38, s48, v23
    s_waitcnt lgkmcnt(2)
    v_mfma_f32_32x32x16_bf16 v[48:63], v[136:139], v[72:75], v[48:63]
    ds_read_b64_tr_b16 v[68:69], v18 offset:37888
    ds_read_b64_tr_b16 v[70:71], v18 offset:38144
    v_exp_f32 v86, v86
    v_exp_f32 v38, v38
    v_add_f32 v24, v24, v85
    v_add_f32_e64 v25, v25, v37
    v_mfma_f32_32x32x16_bf16 v[48:63], v[140:143], v[76:79], v[48:63]
    ds_read_b64_tr_b16 v[72:73], v18 offset:38912
    ds_read_b64_tr_b16 v[74:75], v18 offset:39168
    v_fma_f32 v87, v39, s48, -v22
    v_fma_f32 v39, -v39, s48, v23
    v_exp_f32 v87, v87
    v_exp_f32 v39, v39
    global_store_dwordx4 v19, v[12:15], s[76:77] offset:1024 sc1
    s_waitcnt lgkmcnt(2)
    v_mfma_f32_32x32x16_bf16 v[48:63], v[144:147], v[64:67], v[48:63]
    ds_read_b64_tr_b16 v[76:77], v18 offset:39936
    ds_read_b64_tr_b16 v[78:79], v18 offset:40192
    v_add_f32 v24, v24, v86
    v_add_f32_e64 v25, v25, v38
    v_fma_f32 v88, v40, s48, -v22
    v_fma_f32 v40, -v40, s48, v23
    v_mfma_f32_32x32x16_bf16 v[48:63], v[148:151], v[68:71], v[48:63]
    ds_read_b64_tr_b16 v[64:65], v18 offset:40960
    ds_read_b64_tr_b16 v[66:67], v18 offset:41216
    v_exp_f32 v88, v88
    v_exp_f32 v40, v40
    v_add_f32 v24, v24, v87
    v_add_f32_e64 v25, v25, v39
    s_waitcnt lgkmcnt(2)
    v_mfma_f32_32x32x16_bf16 v[48:63], v[152:155], v[72:75], v[48:63]
    ds_read_b64_tr_b16 v[68:69], v18 offset:41984
    ds_read_b64_tr_b16 v[70:71], v18 offset:42240
    v_fma_f32 v89, v41, s48, -v22
    v_fma_f32 v41, -v41, s48, v23
    v_exp_f32 v89, v89
    v_exp_f32 v41, v41
    s_add_u32 m0, s47, 49152
    v_add_f32_e64 v24, v24, v88
    global_load_lds_dwordx4 v10, s[10:11]
    v_mfma_f32_32x32x16_bf16 v[48:63], v[156:159], v[76:79], v[48:63]
    ds_read_b64_tr_b16 v[72:73], v18 offset:43008
    ds_read_b64_tr_b16 v[74:75], v18 offset:43264
    v_add_f32_e64 v25, v25, v40
    v_fma_f32 v90, v42, s48, -v22
    v_fma_f32 v42, -v42, s48, v23
    v_exp_f32 v90, v90
    s_waitcnt lgkmcnt(2)
    v_mfma_f32_32x32x16_bf16 v[48:63], v[160:163], v[64:67], v[48:63]
    ds_read_b64_tr_b16 v[76:77], v18 offset:44032
    ds_read_b64_tr_b16 v[78:79], v18 offset:44288
    v_exp_f32 v42, v42
    v_add_f32 v24, v24, v89
    v_add_f32_e64 v25, v25, v41
    v_fma_f32 v91, v43, s48, -v22
    v_mfma_f32_32x32x16_bf16 v[48:63], v[164:167], v[68:71], v[48:63]
    ds_read_b64_tr_b16 v[64:65], v18 offset:45056
    ds_read_b64_tr_b16 v[66:67], v18 offset:45312
    v_fma_f32 v43, -v43, s48, v23
    v_exp_f32 v91, v91
    v_exp_f32 v43, v43
    v_add_f32_e64 v24, v24, v90
    s_add_u32 m0, s47, 50176
    v_add_f32_e64 v25, v25, v42
    global_load_lds_dwordx4 v11, s[10:11]
    s_waitcnt lgkmcnt(2)
    v_mfma_f32_32x32x16_bf16 v[48:63], v[168:171], v[72:75], v[48:63]
    ds_read_b64_tr_b16 v[68:69], v18 offset:46080
    ds_read_b64_tr_b16 v[70:71], v18 offset:46336
    v_fma_f32 v92, v44, s48, -v22
    v_fma_f32 v44, -v44, s48, v23
    v_exp_f32 v92, v92
    v_exp_f32_e64 v44, v44
    v_mfma_f32_32x32x16_bf16 v[48:63], v[172:175], v[76:79], v[48:63]
    ds_read_b64_tr_b16 v[72:73], v18 offset:47104
    ds_read_b64_tr_b16 v[74:75], v18 offset:47360
    v_add_f32 v24, v24, v91
    v_add_f32 v25, v25, v43
    v_fma_f32 v93, v45, s48, -v22
    v_fma_f32 v45, -v45, s48, v23
    s_waitcnt lgkmcnt(2)
    v_mfma_f32_32x32x16_bf16 v[48:63], v[176:179], v[64:67], v[48:63]
    ds_read_b64_tr_b16 v[76:77], v18 offset:48128
    ds_read_b64_tr_b16 v[78:79], v18 offset:48384
    v_exp_f32 v93, v93
    v_exp_f32 v45, v45
    v_add_f32 v24, v24, v92
    v_add_f32_e64 v25, v25, v44
    s_add_u32 m0, s47, 51200
    v_fma_f32 v94, v46, s48, -v22
    global_load_lds_dwordx4 v21, s[10:11]
    v_mfma_f32_32x32x16_bf16 v[48:63], v[180:183], v[68:71], v[48:63]
    v_fma_f32 v46, -v46, s48, v23
    v_exp_f32 v94, v94
    v_exp_f32 v46, v46
    v_add_f32 v24, v24, v93
    s_waitcnt lgkmcnt(0)
    v_mfma_f32_32x32x16_bf16 v[48:63], v[184:187], v[72:75], v[48:63]
    v_add_f32_e64 v25, v25, v45
    v_fma_f32 v95, v47, s48, -v22
    v_fma_f32 v47, -v47, s48, v23
    v_exp_f32_e64 v95, v95
    v_mfma_f32_32x32x16_bf16 v[48:63], v[188:191], v[76:79], v[48:63]
    v_exp_f32 v47, v47
    v_add_f32 v24, v24, v94
    v_add_f32 v25, v25, v46
    v_add_f32 v24, v24, v95
    s_add_u32 m0, s47, 52224
    v_add_f32_e64 v25, v25, v47
    global_load_lds_dwordx4 v108, s[10:11]
    s_waitcnt vmcnt(6)
    s_barrier
    ds_read_b64_tr_b16 v[64:65], v18 offset:0
    ds_read_b64_tr_b16 v[66:67], v18 offset:256
    ds_read_b64_tr_b16 v[68:69], v18 offset:1024
    ds_read_b64_tr_b16 v[70:71], v18 offset:1280
    ds_read_b64_tr_b16 v[72:73], v18 offset:2048
    ds_read_b64_tr_b16 v[74:75], v18 offset:2304
    v_rcp_f32 v24, v24
    v_rcp_f32 v25, v25
    v_mul_f32 v80, v24, v80
    v_mul_f32_e64 v81, v24, v81
    s_waitcnt lgkmcnt(2)
    v_mfma_f32_32x32x16_bf16 v[48:63], v[192:195], v[64:67], v[48:63]
    ds_read_b64_tr_b16 v[76:77], v18 offset:3072
    ds_read_b64_tr_b16 v[78:79], v18 offset:3328
    v_mul_f32 v32, v25, v32
    v_mul_f32 v33, v25, v33
    v_cvt_pk_bf16_f32 v80, v80, v81
    v_cvt_pk_bf16_f32 v32, v32, v33
    s_add_u32 m0, s47, 0
    v_mul_f32 v82, v24, v82
    global_load_lds_dwordx4 v10, s[12:13]
    v_mfma_f32_32x32x16_bf16 v[48:63], v[196:199], v[68:71], v[48:63]
    ds_read_b64_tr_b16 v[64:65], v18 offset:4096
    ds_read_b64_tr_b16 v[66:67], v18 offset:4352
    v_mul_f32 v83, v24, v83
    v_mul_f32 v34, v25, v34
    v_mul_f32_e64 v35, v25, v35
    v_cvt_pk_bf16_f32 v81, v82, v83
    s_waitcnt lgkmcnt(2)
    v_mfma_f32_32x32x16_bf16 v[48:63], v[200:203], v[72:75], v[48:63]
    ds_read_b64_tr_b16 v[68:69], v18 offset:5120
    ds_read_b64_tr_b16 v[70:71], v18 offset:5376
    v_cvt_pk_bf16_f32 v33, v34, v35
    v_mul_f32 v84, v24, v84
    v_mul_f32 v85, v24, v85
    v_mul_f32 v36, v25, v36
    v_mfma_f32_32x32x16_bf16 v[48:63], v[204:207], v[76:79], v[48:63]
    ds_read_b64_tr_b16 v[72:73], v18 offset:6144
    ds_read_b64_tr_b16 v[74:75], v18 offset:6400
    v_mul_f32_e64 v37, v25, v37
    v_cvt_pk_bf16_f32 v82, v84, v85
    v_cvt_pk_bf16_f32 v34, v36, v37
    v_mul_f32 v86, v24, v86
    s_waitcnt lgkmcnt(2)
    v_mfma_f32_32x32x16_bf16 v[48:63], v[208:211], v[64:67], v[48:63]
    ds_read_b64_tr_b16 v[76:77], v18 offset:7168
    ds_read_b64_tr_b16 v[78:79], v18 offset:7424
    v_mul_f32 v87, v24, v87
    v_mul_f32 v38, v25, v38
    v_mul_f32_e64 v39, v25, v39
    v_cvt_pk_bf16_f32 v83, v86, v87
    s_add_u32 m0, s47, 1024
    v_cvt_pk_bf16_f32 v35, v38, v39
    global_load_lds_dwordx4 v11, s[12:13]
    v_mfma_f32_32x32x16_bf16 v[48:63], v[212:215], v[68:71], v[48:63]
    ds_read_b64_tr_b16 v[64:65], v18 offset:8192
    ds_read_b64_tr_b16 v[66:67], v18 offset:8448
    v_mul_f32 v88, v24, v88
    v_mul_f32 v89, v24, v89
    v_mul_f32 v40, v25, v40
    v_mul_f32_e64 v41, v25, v41
    s_waitcnt lgkmcnt(2)
    v_mfma_f32_32x32x16_bf16 v[48:63], v[216:219], v[72:75], v[48:63]
    ds_read_b64_tr_b16 v[68:69], v18 offset:9216
    ds_read_b64_tr_b16 v[70:71], v18 offset:9472
    v_cvt_pk_bf16_f32 v84, v88, v89
    v_cvt_pk_bf16_f32 v36, v40, v41
    v_mul_f32 v90, v24, v90
    v_mul_f32 v91, v24, v91
    v_mfma_f32_32x32x16_bf16 v[48:63], v[220:223], v[76:79], v[48:63]
    ds_read_b64_tr_b16 v[72:73], v18 offset:10240
    ds_read_b64_tr_b16 v[74:75], v18 offset:10496
    v_mul_f32 v42, v25, v42
    v_mul_f32 v43, v25, v43
    v_cvt_pk_bf16_f32 v85, v90, v91
    v_cvt_pk_bf16_f32 v37, v42, v43
    s_waitcnt lgkmcnt(2)
    v_mfma_f32_32x32x16_bf16 v[48:63], v[224:227], v[64:67], v[48:63]
    ds_read_b64_tr_b16 v[76:77], v18 offset:11264
    ds_read_b64_tr_b16 v[78:79], v18 offset:11520
    v_mul_f32 v92, v24, v92
    v_mul_f32 v93, v24, v93
    v_mul_f32 v44, v25, v44
    v_mul_f32_e64 v45, v25, v45
    s_add_u32 m0, s47, 2048
    v_cvt_pk_bf16_f32 v86, v92, v93
    global_load_lds_dwordx4 v21, s[12:13]
    v_mfma_f32_32x32x16_bf16 v[48:63], v[228:231], v[68:71], v[48:63]
    ds_read_b64_tr_b16 v[64:65], v18 offset:12288
    ds_read_b64_tr_b16 v[66:67], v18 offset:12544
    v_cvt_pk_bf16_f32 v38, v44, v45
    v_mul_f32 v94, v24, v94
    v_mul_f32 v95, v24, v95
    v_mul_f32 v46, v25, v46
    s_waitcnt lgkmcnt(2)
    v_mfma_f32_32x32x16_bf16 v[48:63], v[232:235], v[72:75], v[48:63]
    ds_read_b64_tr_b16 v[68:69], v18 offset:13312
    ds_read_b64_tr_b16 v[70:71], v18 offset:13568
    v_mul_f32_e64 v47, v25, v47
    v_cvt_pk_bf16_f32 v87, v94, v95
    v_cvt_pk_bf16_f32 v39, v46, v47
    v_mfma_f32_32x32x16_bf16 v[48:63], v[236:239], v[76:79], v[48:63]
    ds_read_b64_tr_b16 v[72:73], v18 offset:14336
    ds_read_b64_tr_b16 v[74:75], v18 offset:14592
    s_waitcnt lgkmcnt(2)
    v_mfma_f32_32x32x16_bf16 v[48:63], v[240:243], v[64:67], v[48:63]
    ds_read_b64_tr_b16 v[76:77], v18 offset:15360
    ds_read_b64_tr_b16 v[78:79], v18 offset:15616
    s_add_u32 m0, s47, 3072
    s_nop 0
    global_load_lds_dwordx4 v108, s[12:13]
    v_mfma_f32_32x32x16_bf16 v[48:63], v[244:247], v[68:71], v[48:63]
    s_waitcnt lgkmcnt(0)
    v_mfma_f32_32x32x16_bf16 v[48:63], v[248:251], v[72:75], v[48:63]
    v_mfma_f32_32x32x16_bf16 v[48:63], v[252:255], v[76:79], v[48:63]
    v_mov_b64 v[88:89], v[32:33]
    v_mov_b64 v[90:91], v[34:35]
    v_mov_b64 v[92:93], v[36:37]
    v_mov_b64_e64 v[94:95], v[38:39]
    v_mfma_f32_32x32x16_bf16 v[64:79], v[80:83], v[112:115], 0
    v_mfma_f32_32x32x16_bf16 v[64:79], v[84:87], v[116:119], v[64:79]
    v_mfma_f32_32x32x16_bf16 v[32:47], v[88:91], v[112:115], 0
    v_mfma_f32_32x32x16_bf16 v[32:47], v[92:95], v[116:119], v[32:47]
    s_nop 3
    s_nop 0
    v_cvt_pk_bf16_f32 v80, v48, v49
    v_cvt_pk_bf16_f32 v81, v50, v51
    v_cvt_pk_bf16_f32 v82, v52, v53
    v_cvt_pk_bf16_f32 v83, v54, v55
    v_cvt_pk_bf16_f32 v84, v56, v57
    v_cvt_pk_bf16_f32 v85, v58, v59
    v_cvt_pk_bf16_f32 v86, v60, v61
    v_cvt_pk_bf16_f32 v87, v62, v63
    v_cvt_pk_bf16_f32 v48, v64, v65
    v_cvt_pk_bf16_f32 v49, v66, v67
    v_cvt_pk_bf16_f32 v50, v68, v69
    v_cvt_pk_bf16_f32 v51, v70, v71
    v_cvt_pk_bf16_f32 v52, v72, v73
    v_cvt_pk_bf16_f32 v53, v74, v75
    v_cvt_pk_bf16_f32 v54, v76, v77
    v_cvt_pk_bf16_f32 v55, v78, v79
    s_mov_b32 vcc_lo, 0xf0f00f0f
    s_mov_b32 vcc_hi, 0xf0f00f0f
    v_mov_b32 v4, 0x3f803f80
    v_cndmask_b32 v112, 0, v4, vcc
    v_cndmask_b32 v113, 0, v4, vcc
    v_cndmask_b32 v114, 0, v4, vcc
    v_cndmask_b32 v115, 0, v4, vcc
    v_mfma_f32_32x32x16_bf16 v[64:79], v[48:51], v[80:83], 0
    v_mfma_f32_32x32x16_bf16 v[64:79], v[52:55], v[84:87], v[64:79]
    v_cvt_pk_bf16_f32 v56, v32, v33
    v_cvt_pk_bf16_f32 v57, v34, v35
    v_cvt_pk_bf16_f32 v58, v36, v37
    v_cvt_pk_bf16_f32 v59, v38, v39
    v_cvt_pk_bf16_f32 v60, v40, v41
    v_cvt_pk_bf16_f32 v61, v42, v43
    v_cvt_pk_bf16_f32 v62, v44, v45
    v_cvt_pk_bf16_f32 v63, v46, v47
    v_mfma_f32_16x16x32_bf16 v[88:91], v[112:115], v[48:51], 0
    v_mfma_f32_16x16x32_bf16 v[88:91], v[112:115], v[52:55], v[88:91]
    v_mfma_f32_32x32x16_bf16 v[32:47], v[56:59], v[80:83], 0
    v_mfma_f32_32x32x16_bf16 v[32:47], v[60:63], v[84:87], v[32:47]
    v_mfma_f32_16x16x32_bf16 v[92:95], v[112:115], v[56:59], 0
    v_mfma_f32_16x16x32_bf16 v[92:95], v[112:115], v[60:63], v[92:95]
    s_add_u32 s41, s47, s51
    v_add_u32 v2, s41, v97
    s_mov_b32 vcc_lo, 0
    s_mov_b32 vcc_hi, -1
    v_mov_b32 v24, 0xffff
    v_cndmask_b32 v48, v64, v72, s[54:55]
    v_cndmask_b32 v49, v65, v73, s[54:55]
    v_cndmask_b32 v50, v66, v74, s[54:55]
    v_cndmask_b32 v51, v67, v75, s[54:55]
    v_cndmask_b32 v52, v68, v76, s[54:55]
    v_cndmask_b32 v53, v69, v77, s[54:55]
    v_cndmask_b32 v54, v70, v78, s[54:55]
    v_cndmask_b32 v55, v71, v79, s[54:55]
    v_cndmask_b32_e64 v4, v88, v92, vcc
    ds_write_b32 v2, v4
    s_cmp_lt_u32 s40, 2
    s_cbranch_scc1 B_red_lo
    s_cmp_eq_u32 s40, 2
    s_cbranch_scc1 B_red_2
    s_branch B_red_3
B_red_lo:
    s_cmp_eq_u32 s40, 1
    s_cbranch_scc1 B_red_1
B_red_0:
    s_nop 0
    ds_write_b128 v96, v[52:55] offset:1024
    v_cndmask_b32 v56, v32, v40, s[54:55]
    v_cndmask_b32 v57, v33, v41, s[54:55]
    v_cndmask_b32 v58, v34, v42, s[54:55]
    v_cndmask_b32 v59, v35, v43, s[54:55]
    v_cndmask_b32 v60, v36, v44, s[54:55]
    v_cndmask_b32 v61, v37, v45, s[54:55]
    v_cndmask_b32 v62, v38, v46, s[54:55]
    v_cndmask_b32 v63, v39, v47, s[54:55]
    ds_write_b128 v96, v[56:59] offset:2048
    ds_write_b128 v96, v[60:63] offset:3072
    s_waitcnt vmcnt(4)
    s_waitcnt lgkmcnt(0)
    s_barrier
    s_nop 0
    ds_read_b128 v[64:67], v111 offset:4096
    ds_read_b128 v[68:71], v111 offset:8192
    ds_read_b128 v[72:75], v111 offset:12288
    ds_read_b32 v80, v97 offset:0
    ds_read_b32 v81, v97 offset:5120
    ds_read_b32 v82, v97 offset:10240
    ds_read_b32 v83, v97 offset:15360
    s_waitcnt lgkmcnt(6)
    v_add_f32 v48, v48, v64
    v_add_f32 v49, v49, v65
    v_add_f32 v50, v50, v66
    v_add_f32 v51, v51, v67
    s_waitcnt lgkmcnt(5)
    v_add_f32 v48, v48, v68
    v_add_f32 v49, v49, v69
    v_add_f32 v50, v50, v70
    v_add_f32 v51, v51, v71
    s_waitcnt lgkmcnt(4)
    v_add_f32 v48, v48, v72
    v_add_f32 v49, v49, v73
    v_add_f32 v50, v50, v74
    v_add_f32_e64 v51, v51, v75
    v_cvt_pk_bf16_f32 v88, v48, v49
    v_cvt_pk_bf16_f32 v89, v50, v51
    s_branch B_red_done
B_red_1:
    s_nop 0
    ds_write_b128 v96, v[48:51] offset:0
    v_cndmask_b32 v56, v32, v40, s[54:55]
    v_cndmask_b32 v57, v33, v41, s[54:55]
    v_cndmask_b32 v58, v34, v42, s[54:55]
    v_cndmask_b32 v59, v35, v43, s[54:55]
    v_cndmask_b32 v60, v36, v44, s[54:55]
    v_cndmask_b32 v61, v37, v45, s[54:55]
    v_cndmask_b32 v62, v38, v46, s[54:55]
    v_cndmask_b32 v63, v39, v47, s[54:55]
    ds_write_b128 v96, v[56:59] offset:2048
    ds_write_b128 v96, v[60:63] offset:3072
    s_waitcnt vmcnt(4)
    s_waitcnt lgkmcnt(0)
    s_barrier
    s_nop 0
    ds_read_b128 v[64:67], v111 offset:0
    ds_read_b128 v[68:71], v111 offset:8192
    ds_read_b128 v[72:75], v111 offset:12288
    ds_read_b32 v80, v97 offset:0
    ds_read_b32 v81, v97 offset:5120
    ds_read_b32 v82, v97 offset:10240
    ds_read_b32 v83, v97 offset:15360
    s_waitcnt lgkmcnt(6)
    v_add_f32 v52, v52, v64
    v_add_f32 v53, v53, v65
    v_add_f32 v54, v54, v66
    v_add_f32 v55, v55, v67
    s_waitcnt lgkmcnt(5)
    v_add_f32 v52, v52, v68
    v_add_f32 v53, v53, v69
    v_add_f32 v54, v54, v70
    v_add_f32 v55, v55, v71
    s_waitcnt lgkmcnt(4)
    v_add_f32 v52, v52, v72
    v_add_f32 v53, v53, v73
    v_add_f32 v54, v54, v74
    v_add_f32_e64 v55, v55, v75
    v_cvt_pk_bf16_f32 v88, v52, v53
    v_cvt_pk_bf16_f32 v89, v54, v55
    s_branch B_red_done
B_red_2:
    s_nop 0
    ds_write_b128 v96, v[48:51] offset:0
    ds_write_b128 v96, v[52:55] offset:1024
    v_cndmask_b32 v56, v32, v40, s[54:55]
    v_cndmask_b32 v57, v33, v41, s[54:55]
    v_cndmask_b32 v58, v34, v42, s[54:55]
    v_cndmask_b32 v59, v35, v43, s[54:55]
    v_cndmask_b32 v60, v36, v44, s[54:55]
    v_cndmask_b32 v61, v37, v45, s[54:55]
    v_cndmask_b32 v62, v38, v46, s[54:55]
    v_cndmask_b32 v63, v39, v47, s[54:55]
    ds_write_b128 v96, v[60:63] offset:3072
    s_waitcnt vmcnt(4)
    s_waitcnt lgkmcnt(0)
    s_barrier
    s_nop 0
    ds_read_b128 v[64:67], v111 offset:0
    ds_read_b128 v[68:71], v111 offset:4096
    ds_read_b128 v[72:75], v111 offset:12288
    ds_read_b32 v80, v97 offset:0
    ds_read_b32 v81, v97 offset:5120
    ds_read_b32 v82, v97 offset:10240
    ds_read_b32 v83, v97 offset:15360
    s_waitcnt lgkmcnt(6)
    v_add_f32 v56, v56, v64
    v_add_f32 v57, v57, v65
    v_add_f32 v58, v58, v66
    v_add_f32 v59, v59, v67
    s_waitcnt lgkmcnt(5)
    v_add_f32 v56, v56, v68
    v_add_f32 v57, v57, v69
    v_add_f32 v58, v58, v70
    v_add_f32 v59, v59, v71
    s_waitcnt lgkmcnt(4)
    v_add_f32 v56, v56, v72
    v_add_f32 v57, v57, v73
    v_add_f32 v58, v58, v74
    v_add_f32_e64 v59, v59, v75
    v_cvt_pk_bf16_f32 v88, v56, v57
    v_cvt_pk_bf16_f32 v89, v58, v59
    s_branch B_red_done
B_red_3:
    s_nop 0
    ds_write_b128 v96, v[48:51] offset:0
    ds_write_b128 v96, v[52:55] offset:1024
    v_cndmask_b32 v56, v32, v40, s[54:55]
    v_cndmask_b32 v57, v33, v41, s[54:55]
    v_cndmask_b32 v58, v34, v42, s[54:55]
    v_cndmask_b32 v59, v35, v43, s[54:55]
    v_cndmask_b32 v60, v36, v44, s[54:55]
    v_cndmask_b32 v61, v37, v45, s[54:55]
    v_cndmask_b32 v62, v38, v46, s[54:55]
    v_cndmask_b32 v63, v39, v47, s[54:55]
    ds_write_b128 v96, v[56:59] offset:2048
    s_waitcnt vmcnt(4)
    s_waitcnt lgkmcnt(0)
    s_barrier
    s_nop 0
    ds_read_b128 v[64:67], v111 offset:0
    ds_read_b128 v[68:71], v111 offset:4096
    ds_read_b128 v[72:75], v111 offset:8192
    ds_read_b32 v80, v97 offset:0
    ds_read_b32 v81, v97 offset:5120
    ds_read_b32 v82, v97 offset:10240
    ds_read_b32 v83, v97 offset:15360
    s_waitcnt lgkmcnt(6)
    v_add_f32 v60, v60, v64
    v_add_f32 v61, v61, v65
    v_add_f32 v62, v62, v66
    v_add_f32 v63, v63, v67
    s_waitcnt lgkmcnt(5)
    v_add_f32 v60, v60, v68
    v_add_f32 v61, v61, v69
    v_add_f32 v62, v62, v70
    v_add_f32 v63, v63, v71
    s_waitcnt lgkmcnt(4)
    v_add_f32 v60, v60, v72
    v_add_f32 v61, v61, v73
    v_add_f32 v62, v62, v74
    v_add_f32_e64 v63, v63, v75
    v_cvt_pk_bf16_f32 v88, v60, v61
    v_cvt_pk_bf16_f32 v89, v62, v63
B_red_done:
    s_waitcnt lgkmcnt(1)
    v_add_f32 v80, v80, v82
    s_waitcnt lgkmcnt(0)
    v_add_f32 v81, v81, v83
    v_add_f32_e64 v90, v80, v81
    v_cvt_pk_bf16_f32 v90, v90, v90
    v_bfi_b32 v90, v24, v5, v90
    global_store_dwordx3 v20, v[88:90], s[4:5] sc1
    s_mov_b64 exec, 1
    global_store_dword v110, v5, s[34:35] sc1
    s_mov_b64 exec, -1
    ds_read_b64_tr_b16 v[48:49], v17 offset:16384
    ds_read_b64_tr_b16 v[50:51], v17 offset:16640
    ds_read_b64_tr_b16 v[52:53], v17 offset:17408
    ds_read_b64_tr_b16 v[54:55], v17 offset:17664
    ds_read_b64_tr_b16 v[56:57], v17 offset:18432
    ds_read_b64_tr_b16 v[58:59], v17 offset:18688
    ds_read_b64_tr_b16 v[60:61], v17 offset:19456
    ds_read_b64_tr_b16 v[62:63], v17 offset:19712
    ds_read_b64_tr_b16 v[64:65], v17 offset:20480
    ds_read_b64_tr_b16 v[66:67], v17 offset:20736
    ds_read_b64_tr_b16 v[68:69], v17 offset:21504
    ds_read_b64_tr_b16 v[70:71], v17 offset:21760
    v_mov_b32 v6, v107
    v_xor_b32 v7, 64, v107
    v_add_u32 v7, 0x2000, v7
    v_add_u32 v8, 0x4000, v6
    v_add_u32 v9, 0x4000, v7
    s_waitcnt lgkmcnt(10)
    v_mfma_f32_32x32x16_bf16 v[32:47], v[48:51], v[128:131], 0
    ds_read_b64_tr_b16 v[72:73], v17 offset:22528
    ds_read_b64_tr_b16 v[74:75], v17 offset:22784
    s_add_u32 s41, s33, 0
    s_and_b32 s41, s41, 3
    s_lshl_b32 s41, s41, 17
    s_add_u32 s14, s78, s41
    s_addc_u32 s15, s79, 0
    s_waitcnt lgkmcnt(10)
    v_mfma_f32_32x32x16_bf16 v[32:47], v[52:55], v[132:135], v[32:47]
    ds_read_b64_tr_b16 v[76:77], v17 offset:23552
    ds_read_b64_tr_b16 v[78:79], v17 offset:23808
    s_add_u32 s41, s33, 1
    s_and_b32 s41, s41, 3
    s_lshl_b32 s41, s41, 17
    s_add_u32 s16, s78, s41
    s_addc_u32 s17, s79, 0
    s_waitcnt lgkmcnt(10)
    v_mfma_f32_32x32x16_bf16 v[32:47], v[56:59], v[136:139], v[32:47]
    ds_read_b64_tr_b16 v[48:49], v17 offset:24576
    ds_read_b64_tr_b16 v[50:51], v17 offset:24832
    s_add_u32 s41, s33, 2
    s_and_b32 s41, s41, 3
    s_lshl_b32 s41, s41, 17
    s_add_u32 s18, s78, s41
    s_addc_u32 s19, s79, 0
    s_waitcnt lgkmcnt(10)
    v_mfma_f32_32x32x16_bf16 v[32:47], v[60:63], v[140:143], v[32:47]
    ds_read_b64_tr_b16 v[52:53], v17 offset:25600
    ds_read_b64_tr_b16 v[54:55], v17 offset:25856
    s_add_u32 s41, s33, 3
    s_and_b32 s41, s41, 3
    s_lshl_b32 s41, s41, 17
    s_add_u32 s20, s78, s41
    s_addc_u32 s21, s79, 0
    s_waitcnt lgkmcnt(10)
    v_mfma_f32_32x32x16_bf16 v[32:47], v[64:67], v[144:147], v[32:47]
    ds_read_b64_tr_b16 v[56:57], v17 offset:26624
    ds_read_b64_tr_b16 v[58:59], v17 offset:26880
    v_bfe_u32 v2, v1, 2, 2
    v_lshrrev_b32 v3, 4, v1
    v_and_b32 v4, 1, v1
    v_lshlrev_b32 v4, 4, v4
    v_mov_b32 v114, 0x3f80
    s_add_u32 m0, s47, 65536
    s_nop 0
    global_load_lds_dwordx4 v6, s[14:15]
    s_waitcnt lgkmcnt(10)
    v_mfma_f32_32x32x16_bf16 v[32:47], v[68:71], v[148:151], v[32:47]
    ds_read_b64_tr_b16 v[60:61], v17 offset:27648
    ds_read_b64_tr_b16 v[62:63], v17 offset:27904
    v_lshlrev_b32 v4, v4, v114
    v_cmp_eq_u32 vcc, v2, v3
    s_nop 1
    v_cndmask_b32 v4, 0, v4, vcc
    v_and_b32 v2, 2, v1
    v_mov_b32_e64 v114, 0
    s_waitcnt lgkmcnt(10)
    v_mfma_f32_32x32x16_bf16 v[32:47], v[72:75], v[152:155], v[32:47]
    ds_read_b64_tr_b16 v[64:65], v17 offset:28672
    ds_read_b64_tr_b16 v[66:67], v17 offset:28928
    v_cmp_eq_u32 vcc, 0, v2
    s_nop 1
    v_cndmask_b32_e64 v112, 0, v4, vcc
    v_cndmask_b32 v113, v4, 0, vcc
    v_mov_b32 v115, 0
    s_waitcnt lgkmcnt(10)
    v_mfma_f32_32x32x16_bf16 v[32:47], v[76:79], v[156:159], v[32:47]
    ds_read_b64_tr_b16 v[68:69], v17 offset:29696
    ds_read_b64_tr_b16 v[70:71], v17 offset:29952
    s_add_u32 m0, s47, 66560
    s_nop 0
    global_load_lds_dwordx4 v7, s[14:15]
    s_waitcnt lgkmcnt(10)
    v_mfma_f32_32x32x16_bf16 v[32:47], v[48:51], v[160:163], v[32:47]
    ds_read_b64_tr_b16 v[72:73], v17 offset:30720
    ds_read_b64_tr_b16 v[74:75], v17 offset:30976
    s_waitcnt lgkmcnt(10)
    v_mfma_f32_32x32x16_bf16 v[32:47], v[52:55], v[164:167], v[32:47]
    ds_read_b64_tr_b16 v[76:77], v17 offset:31744
    ds_read_b64_tr_b16 v[78:79], v17 offset:32000
    s_waitcnt lgkmcnt(10)
    v_mfma_f32_32x32x16_bf16 v[32:47], v[56:59], v[168:171], v[32:47]
    s_add_u32 m0, s47, 67584
    s_nop 0
    global_load_lds_dwordx4 v8, s[14:15]
    s_waitcnt lgkmcnt(8)
    v_mfma_f32_32x32x16_bf16 v[32:47], v[60:63], v[172:175], v[32:47]
    s_waitcnt lgkmcnt(6)
    v_mfma_f32_32x32x16_bf16 v[32:47], v[64:67], v[176:179], v[32:47]
    s_waitcnt lgkmcnt(4)
    v_mfma_f32_32x32x16_bf16 v[32:47], v[68:71], v[180:183], v[32:47]
    s_add_u32 m0, s47, 68608
    s_nop 0
    global_load_lds_dwordx4 v9, s[14:15]
    s_waitcnt lgkmcnt(2)
    v_mfma_f32_32x32x16_bf16 v[32:47], v[72:75], v[184:187], v[32:47]
    s_waitcnt lgkmcnt(0)
    v_mfma_f32_32x32x16_bf16 v[32:47], v[76:79], v[188:191], v[32:47]
    s_waitcnt vmcnt(6)
    v_add_u32 v21, 6144, v20
    s_barrier
    s_nop 0
    ds_read_b64_tr_b16 v[48:49], v16 offset:0
    ds_read_b64_tr_b16 v[50:51], v16 offset:256
    ds_read_b64_tr_b16 v[52:53], v16 offset:1024
    ds_read_b64_tr_b16 v[54:55], v16 offset:1280
    ds_read_b64_tr_b16 v[56:57], v16 offset:2048
    ds_read_b64_tr_b16 v[58:59], v16 offset:2304
    ds_read_b64_tr_b16 v[60:61], v16 offset:3072
    ds_read_b64_tr_b16 v[62:63], v16 offset:3328
    ds_read_b64_tr_b16 v[64:65], v16 offset:4096
    ds_read_b64_tr_b16 v[66:67], v16 offset:4352
    ds_read_b64_tr_b16 v[68:69], v16 offset:5120
    ds_read_b64_tr_b16 v[70:71], v16 offset:5376
    s_waitcnt lgkmcnt(10)
    v_mfma_f32_32x32x16_bf16 v[32:47], v[48:51], v[192:195], v[32:47]
    ds_read_b64_tr_b16 v[72:73], v16 offset:6144
    ds_read_b64_tr_b16 v[74:75], v16 offset:6400
    s_waitcnt lgkmcnt(10)
    v_mfma_f32_32x32x16_bf16 v[32:47], v[52:55], v[196:199], v[32:47]
    ds_read_b64_tr_b16 v[76:77], v16 offset:7168
    ds_read_b64_tr_b16 v[78:79], v16 offset:7424
    s_add_u32 m0, s47, 32768
    s_nop 0
    global_load_lds_dwordx4 v6, s[16:17]
    s_waitcnt lgkmcnt(10)
    v_mfma_f32_32x32x16_bf16 v[32:47], v[56:59], v[200:203], v[32:47]
    ds_read_b64_tr_b16 v[48:49], v16 offset:8192
    ds_read_b64_tr_b16 v[50:51], v16 offset:8448
    s_waitcnt lgkmcnt(10)
    v_mfma_f32_32x32x16_bf16 v[32:47], v[60:63], v[204:207], v[32:47]
    ds_read_b64_tr_b16 v[52:53], v16 offset:9216
    ds_read_b64_tr_b16 v[54:55], v16 offset:9472
    s_waitcnt lgkmcnt(10)
    v_mfma_f32_32x32x16_bf16 v[32:47], v[64:67], v[208:211], v[32:47]
    ds_read_b64_tr_b16 v[56:57], v16 offset:10240
    ds_read_b64_tr_b16 v[58:59], v16 offset:10496
    s_add_u32 m0, s47, 33792
    s_nop 0
    global_load_lds_dwordx4 v7, s[16:17]
    s_waitcnt lgkmcnt(10)
    v_mfma_f32_32x32x16_bf16 v[32:47], v[68:71], v[212:215], v[32:47]
    ds_read_b64_tr_b16 v[60:61], v16 offset:11264
    ds_read_b64_tr_b16 v[62:63], v16 offset:11520
    s_waitcnt lgkmcnt(10)
    v_mfma_f32_32x32x16_bf16 v[32:47], v[72:75], v[216:219], v[32:47]
    ds_read_b64_tr_b16 v[64:65], v16 offset:12288
    ds_read_b64_tr_b16 v[66:67], v16 offset:12544
    s_waitcnt lgkmcnt(10)
    v_mfma_f32_32x32x16_bf16 v[32:47], v[76:79], v[220:223], v[32:47]
    ds_read_b64_tr_b16 v[68:69], v16 offset:13312
    ds_read_b64_tr_b16 v[70:71], v16 offset:13568
    s_add_u32 m0, s47, 34816
    s_nop 0
    global_load_lds_dwordx4 v8, s[16:17]
    s_waitcnt lgkmcnt(10)
    v_mfma_f32_32x32x16_bf16 v[32:47], v[48:51], v[224:227], v[32:47]
    ds_read_b64_tr_b16 v[72:73], v16 offset:14336
    ds_read_b64_tr_b16 v[74:75], v16 offset:14592
    s_waitcnt lgkmcnt(10)
    v_mfma_f32_32x32x16_bf16 v[32:47], v[52:55], v[228:231], v[32:47]
    ds_read_b64_tr_b16 v[76:77], v16 offset:15360
    ds_read_b64_tr_b16 v[78:79], v16 offset:15616
    s_waitcnt lgkmcnt(10)
    v_mfma_f32_32x32x16_bf16 v[32:47], v[56:59], v[232:235], v[32:47]
    s_add_u32 m0, s47, 35840
    s_nop 0
    global_load_lds_dwordx4 v9, s[16:17]
    s_waitcnt lgkmcnt(8)
    v_mfma_f32_32x32x16_bf16 v[32:47], v[60:63], v[236:239], v[32:47]
    s_waitcnt lgkmcnt(6)
    v_mfma_f32_32x32x16_bf16 v[32:47], v[64:67], v[240:243], v[32:47]
    s_waitcnt lgkmcnt(4)
    v_mfma_f32_32x32x16_bf16 v[32:47], v[68:71], v[244:247], v[32:47]
    s_waitcnt lgkmcnt(2)
    v_mfma_f32_32x32x16_bf16 v[32:47], v[72:75], v[248:251], v[32:47]
    s_waitcnt lgkmcnt(0)
    v_mfma_f32_32x32x16_bf16 v[32:47], v[76:79], v[252:255], v[32:47]
    s_barrier
    global_load_dwordx3 v[128:130], v20, s[56:57] offset:-3072 sc1
    s_nop 9
    v_cvt_pk_bf16_f32 v64, v32, v33
    v_cvt_pk_bf16_f32 v65, v34, v35
    v_cvt_pk_bf16_f32 v66, v36, v37
    v_cvt_pk_bf16_f32 v67, v38, v39
    v_cvt_pk_bf16_f32 v68, v40, v41
    v_cvt_pk_bf16_f32 v69, v42, v43
    v_cvt_pk_bf16_f32 v70, v44, v45
    v_cvt_pk_bf16_f32 v71, v46, v47
    v_mfma_f32_32x32x16_bf16 v[32:47], v[120:123], v[64:67], 0
    s_nop 0
    v_mfma_f32_32x32x16_bf16 v[32:47], v[124:127], v[68:71], v[32:47]
    global_load_dwordx3 v[132:134], v20, s[56:57] offset:0 sc1
    global_load_dwordx3 v[136:138], v21, s[56:57] offset:-3072 sc1
    v_lshlrev_b32 v2, 2, v26
    v_mov_b32 v4, 0x3f803f80
    v_cndmask_b32 v4, 0, v4, s[54:55]
    ds_write_b32 v2, v4 offset:19072
    s_nop 5
    s_nop 0
    v_max3_f32 v22, v32, v33, v34
    v_min3_f32 v23, v32, v33, v34
    v_max3_f32 v22, v22, v35, v36
    v_min3_f32 v23, v23, v35, v36
    v_max3_f32 v22, v22, v37, v38
    v_min3_f32 v23, v23, v37, v38
    v_max3_f32 v22, v22, v39, v40
    global_load_dwordx3 v[140:142], v21, s[56:57] offset:0 sc1
    v_min3_f32 v23, v23, v39, v40
    v_max3_f32 v22, v22, v41, v42
    v_min3_f32 v23, v23, v41, v42
    v_max3_f32 v22, v22, v43, v44
    v_min3_f32 v23, v23, v43, v44
    v_max3_f32 v22, v22, v45, v46
    v_min3_f32 v23, v23, v45, v46
    global_load_dwordx3 v[144:146], v20, s[58:59] offset:-3072 sc1
    v_max_f32 v22, v22, v47
    v_min_f32 v23, v23, v47
    v_mul_f32 v22, s48, v22
    v_mul_f32 v23, s48, v23
    v_fma_f32 v80, v32, s48, -v22
    v_fma_f32 v32, -v32, s48, v23
    v_exp_f32_e64 v80, v80
    global_load_dwordx3 v[148:150], v20, s[58:59] offset:0 sc1
    v_exp_f32_e64 v32, v32
    v_fma_f32 v81, v33, s48, -v22
    v_fma_f32 v33, -v33, s48, v23
    v_exp_f32 v81, v81
    v_exp_f32 v33, v33
    v_fma_f32 v82, v34, s48, -v22
    v_fma_f32 v34, -v34, s48, v23
    global_load_dwordx3 v[152:154], v21, s[58:59] offset:-3072 sc1
    v_exp_f32 v82, v82
    v_exp_f32 v34, v34
    v_fma_f32 v83, v35, s48, -v22
    v_fma_f32 v35, -v35, s48, v23
    v_exp_f32 v83, v83
    v_exp_f32 v35, v35
    v_fma_f32 v84, v36, s48, -v22
    global_load_dwordx3 v[156:158], v21, s[58:59] offset:0 sc1
    v_fma_f32 v36, -v36, s48, v23
    v_exp_f32 v84, v84
    v_exp_f32 v36, v36
    v_fma_f32 v85, v37, s48, -v22
    v_fma_f32 v37, -v37, s48, v23
    v_exp_f32 v85, v85
    v_exp_f32 v37, v37
    global_load_dwordx3 v[160:162], v20, s[60:61] offset:-3072 sc1
    v_fma_f32 v86, v38, s48, -v22
    v_fma_f32 v38, -v38, s48, v23
    v_exp_f32 v86, v86
    v_exp_f32 v38, v38
    v_fma_f32 v87, v39, s48, -v22
    v_fma_f32 v39, -v39, s48, v23
    v_exp_f32_e64 v87, v87
    global_load_dwordx3 v[164:166], v20, s[60:61] offset:0 sc1
    v_exp_f32_e64 v39, v39
    v_fma_f32 v88, v40, s48, -v22
    v_fma_f32 v40, -v40, s48, v23
    v_exp_f32 v88, v88
    v_exp_f32 v40, v40
    v_fma_f32 v89, v41, s48, -v22
    v_fma_f32 v41, -v41, s48, v23
    global_load_dwordx3 v[168:170], v21, s[60:61] offset:-3072 sc1
    v_exp_f32 v89, v89
    v_exp_f32 v41, v41
    v_fma_f32 v90, v42, s48, -v22
    v_fma_f32 v42, -v42, s48, v23
    v_exp_f32 v90, v90
    v_exp_f32 v42, v42
    v_fma_f32 v91, v43, s48, -v22
    global_load_dwordx3 v[172:174], v21, s[60:61] offset:0 sc1
    v_fma_f32 v43, -v43, s48, v23
    v_exp_f32 v91, v91
    v_exp_f32 v43, v43
    v_fma_f32 v92, v44, s48, -v22
    v_fma_f32 v44, -v44, s48, v23
    v_exp_f32 v92, v92
    v_exp_f32 v44, v44
    global_load_dwordx3 v[176:178], v20, s[62:63] offset:-3072 sc1
    v_fma_f32 v93, v45, s48, -v22
    v_fma_f32 v45, -v45, s48, v23
    v_exp_f32 v93, v93
    v_exp_f32 v45, v45
    v_fma_f32 v94, v46, s48, -v22
    v_fma_f32 v46, -v46, s48, v23
    v_exp_f32_e64 v94, v94
    global_load_dwordx3 v[180:182], v20, s[62:63] offset:0 sc1
    v_exp_f32_e64 v46, v46
    v_fma_f32 v95, v47, s48, -v22
    v_fma_f32 v47, -v47, s48, v23
    v_exp_f32 v95, v95
    v_exp_f32 v47, v47
    v_cvt_pk_bf16_f32 v80, v80, v81
    v_cvt_pk_bf16_f32 v32, v32, v33
    global_load_dwordx3 v[184:186], v21, s[62:63] offset:-3072 sc1
    v_cvt_pk_bf16_f32 v81, v82, v83
    v_cvt_pk_bf16_f32 v33, v34, v35
    v_cvt_pk_bf16_f32 v82, v84, v85
    v_cvt_pk_bf16_f32 v34, v36, v37
    v_cvt_pk_bf16_f32 v83, v86, v87
    v_cvt_pk_bf16_f32 v35, v38, v39
    v_cvt_pk_bf16_f32 v84, v88, v89
    global_load_dwordx3 v[188:190], v21, s[62:63] offset:0 sc1
    v_cvt_pk_bf16_f32 v36, v40, v41
    v_cvt_pk_bf16_f32 v85, v90, v91
    v_cvt_pk_bf16_f32 v37, v42, v43
    v_cvt_pk_bf16_f32 v86, v92, v93
    v_cvt_pk_bf16_f32 v38, v44, v45
    v_cvt_pk_bf16_f32 v87, v94, v95
    v_cvt_pk_bf16_f32 v39, v46, v47
    s_waitcnt vmcnt(15)
    v_mfma_f32_16x16x32_bf16 v[48:51], v[112:115], v[128:131], 0
    v_and_b32 v52, 0xffff0000, v130
    v_xor_b32_e64 v53, v5, v130
    s_waitcnt vmcnt(14)
    v_mfma_f32_16x16x32_bf16 v[48:51], v[112:115], v[132:135], v[48:51]
    v_and_b32 v56, 0xffff0000, v134
    v_bitop3_b32 v53, v5, v134, v53 bitop3:0xbe
    v_add_f32 v52, v52, v56
    s_waitcnt vmcnt(13)
    v_mfma_f32_16x16x32_bf16 v[48:51], v[112:115], v[136:139], v[48:51]
    v_and_b32 v56, 0xffff0000, v138
    v_bitop3_b32 v53, v5, v138, v53 bitop3:0xbe
    v_add_f32 v52, v52, v56
    s_waitcnt vmcnt(12)
    v_mfma_f32_16x16x32_bf16 v[48:51], v[112:115], v[140:143], v[48:51]
    v_and_b32 v56, 0xffff0000, v142
    v_bitop3_b32 v53, v5, v142, v53 bitop3:0xbe
    v_add_f32 v52, v52, v56
    s_waitcnt vmcnt(11)
    v_mfma_f32_16x16x32_bf16 v[48:51], v[112:115], v[144:147], v[48:51]
    v_and_b32 v56, 0xffff0000, v146
    v_bitop3_b32 v53, v5, v146, v53 bitop3:0xbe
    v_add_f32 v52, v52, v56
    s_waitcnt vmcnt(10)
    v_mfma_f32_16x16x32_bf16 v[48:51], v[112:115], v[148:151], v[48:51]
    v_and_b32 v56, 0xffff0000, v150
    v_bitop3_b32 v53, v5, v150, v53 bitop3:0xbe
    v_add_f32 v52, v52, v56
    s_waitcnt vmcnt(9)
    v_mfma_f32_16x16x32_bf16 v[48:51], v[112:115], v[152:155], v[48:51]
    v_and_b32 v56, 0xffff0000, v154
    v_bitop3_b32 v53, v5, v154, v53 bitop3:0xbe
    v_add_f32 v52, v52, v56
    s_waitcnt vmcnt(8)
    v_mfma_f32_16x16x32_bf16 v[48:51], v[112:115], v[156:159], v[48:51]
    v_and_b32 v56, 0xffff0000, v158
    v_bitop3_b32 v53, v5, v158, v53 bitop3:0xbe
    v_add_f32 v52, v52, v56
    s_waitcnt vmcnt(7)
    v_mfma_f32_16x16x32_bf16 v[48:51], v[112:115], v[160:163], v[48:51]
    v_and_b32 v56, 0xffff0000, v162
    v_bitop3_b32 v53, v5, v162, v53 bitop3:0xbe
    v_add_f32 v52, v52, v56
    s_waitcnt vmcnt(6)
    v_mfma_f32_16x16x32_bf16 v[48:51], v[112:115], v[164:167], v[48:51]
    v_and_b32 v56, 0xffff0000, v166
    v_bitop3_b32 v53, v5, v166, v53 bitop3:0xbe
    v_add_f32 v52, v52, v56
    s_waitcnt vmcnt(5)
    v_mfma_f32_16x16x32_bf16 v[48:51], v[112:115], v[168:171], v[48:51]
    v_and_b32 v56, 0xffff0000, v170
    v_bitop3_b32 v53, v5, v170, v53 bitop3:0xbe
    v_add_f32 v52, v52, v56
    s_waitcnt vmcnt(4)
    v_mfma_f32_16x16x32_bf16 v[48:51], v[112:115], v[172:175], v[48:51]
    v_and_b32 v56, 0xffff0000, v174
    v_bitop3_b32 v53, v5, v174, v53 bitop3:0xbe
    v_add_f32 v52, v52, v56
    s_waitcnt vmcnt(3)
    v_mfma_f32_16x16x32_bf16 v[48:51], v[112:115], v[176:179], v[48:51]
    v_and_b32 v56, 0xffff0000, v178
    v_bitop3_b32 v53, v5, v178, v53 bitop3:0xbe
    v_add_f32 v52, v52, v56
    s_waitcnt vmcnt(2)
    v_mfma_f32_16x16x32_bf16 v[48:51], v[112:115], v[180:183], v[48:51]
    v_and_b32 v56, 0xffff0000, v182
    v_bitop3_b32 v53, v5, v182, v53 bitop3:0xbe
    v_add_f32 v52, v52, v56
    s_waitcnt vmcnt(1)
    v_mfma_f32_16x16x32_bf16 v[48:51], v[112:115], v[184:187], v[48:51]
    v_and_b32 v56, 0xffff0000, v186
    v_bitop3_b32 v53, v5, v186, v53 bitop3:0xbe
    v_add_f32 v52, v52, v56
    s_waitcnt vmcnt(0)
    v_mfma_f32_16x16x32_bf16 v[48:51], v[112:115], v[188:191], v[48:51]
    v_and_b32 v56, 0xffff0000, v190
    v_bitop3_b32 v53, v5, v190, v53 bitop3:0xbe
    v_add_f32_e64 v52, v52, v56
    v_and_b32 v53, 0xffff, v53
    v_cmp_ne_u32 vcc, 0, v53
    s_nop 0
    s_cbranch_vccnz B_kv_r
B_kv_k:
    s_nop 0
    v_cvt_pk_bf16_f32 v56, v48, v49
    v_cvt_pk_bf16_f32 v57, v50, v51
    v_cvt_pk_bf16_f32 v58, v52, v52
    ds_write_b64 v98, v[56:57]
    ds_write_b16 v99, v58
    global_load_dword v110, v109, s[34:35] sc1
    s_waitcnt lgkmcnt(0)
    s_barrier
    ds_read_b128 v[144:147], v101 offset:0
    ds_read_b128 v[128:131], v100 offset:0
    ds_read_b128 v[148:151], v101 offset:16
    ds_read_b128 v[132:135], v100 offset:16
    ds_read_b128 v[152:155], v101 offset:32
    ds_read_b128 v[136:139], v100 offset:32
    ds_read_b128 v[156:159], v101 offset:48
    ds_read_b128 v[140:143], v100 offset:48
    s_waitcnt lgkmcnt(7)
    v_mfma_f32_16x16x32_bf16 v[48:51], v[144:147], v[80:83], 0
    s_waitcnt lgkmcnt(6)
    v_mfma_f32_32x32x16_bf16 v[64:79], v[128:131], v[80:83], 0
    s_waitcnt lgkmcnt(5)
    v_mfma_f32_16x16x32_bf16 v[48:51], v[148:151], v[84:87], v[48:51]
    s_waitcnt lgkmcnt(4)
    v_mfma_f32_32x32x16_bf16 v[64:79], v[132:135], v[84:87], v[64:79]
    s_waitcnt lgkmcnt(3)
    v_mfma_f32_16x16x32_bf16 v[52:55], v[152:155], v[32:35], 0
    s_waitcnt lgkmcnt(2)
    v_mfma_f32_32x32x16_bf16 v[160:175], v[136:139], v[32:35], 0
    s_waitcnt lgkmcnt(1)
    v_mfma_f32_16x16x32_bf16 v[52:55], v[156:159], v[36:39], v[52:55]
    s_waitcnt lgkmcnt(0)
    v_mfma_f32_32x32x16_bf16 v[160:175], v[140:143], v[36:39], v[160:175]
    v_xor_b32_e64 v12, 0, v102
    v_add_u32 v26, 32768, v12
    v_xor_b32_e64 v13, 32, v102
    v_add_u32 v27, 32768, v13
    v_xor_b32_e64 v14, 64, v102
    v_add_u32 v28, 32768, v14
    v_xor_b32 v15, 96, v102
    v_add_u32 v29, 32768, v15
    v_mul_f32 v48, v48, v53
    v_mul_f32 v50, v49, v53
    v_fmac_f32_e64 v48, v52, v49
    v_fmac_f32 v48, 0x358637bd, v50
    v_rcp_f32 v48, v48
    s_nop 0
    v_mul_f32 v53, v48, v53
    v_mul_f32 v49, v48, v49
    v_mul_f32 v64, v53, v64
    v_mul_f32 v65, v53, v65
    v_fmac_f32 v64, v49, v160
    v_fmac_f32 v65, v49, v161
    v_cvt_pk_bf16_f32 v88, v64, v65
    v_mul_f32 v66, v53, v66
    v_mul_f32 v67, v53, v67
    v_fmac_f32 v66, v49, v162
    v_fmac_f32 v67, v49, v163
    v_cvt_pk_bf16_f32 v89, v66, v67
    v_mul_f32 v68, v53, v68
    v_mul_f32 v69, v53, v69
    v_fmac_f32 v68, v49, v164
    v_fmac_f32 v69, v49, v165
    v_cvt_pk_bf16_f32 v90, v68, v69
    v_mul_f32 v70, v53, v70
    v_mul_f32 v71, v53, v71
    v_fmac_f32 v70, v49, v166
    v_fmac_f32 v71, v49, v167
    v_cvt_pk_bf16_f32 v91, v70, v71
    global_store_dwordx4 v19, v[88:91], s[76:77] sc1
    v_mul_f32 v72, v53, v72
    v_mul_f32 v73, v53, v73
    v_fmac_f32 v72, v49, v168
    v_fmac_f32 v73, v49, v169
    v_cvt_pk_bf16_f32 v92, v72, v73
    v_mul_f32 v74, v53, v74
    v_mul_f32 v75, v53, v75
    v_fmac_f32 v74, v49, v170
    v_fmac_f32 v75, v49, v171
    v_cvt_pk_bf16_f32 v93, v74, v75
    v_mul_f32 v76, v53, v76
    v_mul_f32 v77, v53, v77
    v_fmac_f32 v76, v49, v172
    v_fmac_f32 v77, v49, v173
    v_cvt_pk_bf16_f32 v94, v76, v77
    v_mul_f32 v78, v53, v78
    v_mul_f32 v79, v53, v79
    v_fmac_f32 v78, v49, v174
    v_fmac_f32 v79, v49, v175
    v_cvt_pk_bf16_f32 v95, v78, v79
    global_store_dwordx4 v19, v[92:95], s[76:77] offset:1024 sc1
    s_add_u32 m0, s47, 49152
    s_nop 0
    s_nop 0
    global_load_lds_dwordx4 v6, s[18:19]
    ds_read_b64_tr_b16 v[48:49], v26 offset:32768
    ds_read_b64_tr_b16 v[50:51], v26 offset:33280
    ds_read_b64_tr_b16 v[52:53], v27 offset:32768
    ds_read_b64_tr_b16 v[54:55], v27 offset:33280
    ds_read_b64_tr_b16 v[56:57], v28 offset:32768
    ds_read_b64_tr_b16 v[58:59], v28 offset:33280
    ds_read_b64_tr_b16 v[60:61], v29 offset:32768
    ds_read_b64_tr_b16 v[62:63], v29 offset:33280
    s_add_u32 m0, s47, 50176
    s_nop 0
    s_nop 0
    global_load_lds_dwordx4 v7, s[18:19]
    ds_read_b64_tr_b16 v[64:65], v26 offset:36864
    ds_read_b64_tr_b16 v[66:67], v26 offset:37376
    ds_read_b64_tr_b16 v[68:69], v27 offset:36864
    ds_read_b64_tr_b16 v[70:71], v27 offset:37376
    ds_read_b64_tr_b16 v[72:73], v28 offset:36864
    ds_read_b64_tr_b16 v[74:75], v28 offset:37376
    ds_read_b64_tr_b16 v[76:77], v29 offset:36864
    ds_read_b64_tr_b16 v[78:79], v29 offset:37376
    s_add_u32 m0, s47, 51200
    s_nop 0
    s_nop 0
    global_load_lds_dwordx4 v8, s[18:19]
    ds_read_b64_tr_b16 v[112:113], v26 offset:40960
    ds_read_b64_tr_b16 v[114:115], v26 offset:41472
    ds_read_b64_tr_b16 v[116:117], v27 offset:40960
    ds_read_b64_tr_b16 v[118:119], v27 offset:41472
    ds_read_b64_tr_b16 v[120:121], v28 offset:40960
    ds_read_b64_tr_b16 v[122:123], v28 offset:41472
    ds_read_b64_tr_b16 v[124:125], v29 offset:40960
    ds_read_b64_tr_b16 v[126:127], v29 offset:41472
    s_add_u32 m0, s47, 52224
    s_nop 0
    s_nop 0
    global_load_lds_dwordx4 v9, s[18:19]
    ds_read_b64_tr_b16 v[128:129], v26 offset:45056
    ds_read_b64_tr_b16 v[130:131], v26 offset:45568
    ds_read_b64_tr_b16 v[132:133], v27 offset:45056
    ds_read_b64_tr_b16 v[134:135], v27 offset:45568
    ds_read_b64_tr_b16 v[136:137], v28 offset:45056
    ds_read_b64_tr_b16 v[138:139], v28 offset:45568
    ds_read_b64_tr_b16 v[140:141], v29 offset:45056
    ds_read_b64_tr_b16 v[142:143], v29 offset:45568
    s_add_u32 m0, s47, 0
    s_nop 0
    global_load_lds_dwordx4 v6, s[20:21]
    ds_read_b64_tr_b16 v[144:145], v26 offset:0
    ds_read_b64_tr_b16 v[146:147], v26 offset:512
    ds_read_b64_tr_b16 v[148:149], v27 offset:0
    ds_read_b64_tr_b16 v[150:151], v27 offset:512
    ds_read_b64_tr_b16 v[152:153], v28 offset:0
    ds_read_b64_tr_b16 v[154:155], v28 offset:512
    ds_read_b64_tr_b16 v[156:157], v29 offset:0
    ds_read_b64_tr_b16 v[158:159], v29 offset:512
    s_add_u32 m0, s47, 1024
    s_nop 0
    s_nop 0
    global_load_lds_dwordx4 v7, s[20:21]
    ds_read_b64_tr_b16 v[160:161], v26 offset:4096
    ds_read_b64_tr_b16 v[162:163], v26 offset:4608
    ds_read_b64_tr_b16 v[164:165], v27 offset:4096
    ds_read_b64_tr_b16 v[166:167], v27 offset:4608
    ds_read_b64_tr_b16 v[168:169], v28 offset:4096
    ds_read_b64_tr_b16 v[170:171], v28 offset:4608
    ds_read_b64_tr_b16 v[172:173], v29 offset:4096
    ds_read_b64_tr_b16 v[174:175], v29 offset:4608
    s_add_u32 m0, s47, 2048
    s_nop 0
    s_nop 0
    global_load_lds_dwordx4 v8, s[20:21]
    ds_read_b64_tr_b16 v[176:177], v26 offset:8192
    ds_read_b64_tr_b16 v[178:179], v26 offset:8704
    ds_read_b64_tr_b16 v[180:181], v27 offset:8192
    ds_read_b64_tr_b16 v[182:183], v27 offset:8704
    ds_read_b64_tr_b16 v[184:185], v28 offset:8192
    ds_read_b64_tr_b16 v[186:187], v28 offset:8704
    ds_read_b64_tr_b16 v[188:189], v29 offset:8192
    ds_read_b64_tr_b16 v[190:191], v29 offset:8704
    s_add_u32 m0, s47, 3072
    s_nop 0
    s_nop 0
    global_load_lds_dwordx4 v9, s[20:21]
    ds_read_b64_tr_b16 v[80:81], v26 offset:12288
    ds_read_b64_tr_b16 v[82:83], v26 offset:12800
    ds_read_b64_tr_b16 v[84:85], v27 offset:12288
    ds_read_b64_tr_b16 v[86:87], v27 offset:12800
    ds_read_b64_tr_b16 v[88:89], v28 offset:12288
    ds_read_b64_tr_b16 v[90:91], v28 offset:12800
    ds_read_b64_tr_b16 v[92:93], v29 offset:12288
    ds_read_b64_tr_b16 v[94:95], v29 offset:12800
    s_waitcnt vmcnt(10)
    v_cmp_ne_u32 vcc, s44, v110
    s_nop 0
    s_cbranch_vccnz B_fc_r
B_fc_k:
    s_waitcnt vmcnt(8)
    s_barrier
    global_load_dwordx4 v[192:195], v103, s[68:69] offset:-4096 sc1
    global_load_dwordx4 v[196:199], v103, s[68:69] offset:-2048 sc1
    global_load_dwordx4 v[200:203], v103, s[68:69] offset:0 sc1
    global_load_dwordx4 v[204:207], v103, s[68:69] offset:2048 sc1
    global_load_dwordx4 v[208:211], v103, s[70:71] offset:-4096 sc1
    global_load_dwordx4 v[212:215], v103, s[70:71] offset:-2048 sc1
    global_load_dwordx4 v[216:219], v103, s[70:71] offset:0 sc1
    global_load_dwordx4 v[220:223], v103, s[70:71] offset:2048 sc1
    global_load_dwordx4 v[224:227], v103, s[72:73] offset:-4096 sc1
    global_load_dwordx4 v[228:231], v103, s[72:73] offset:-2048 sc1
    s_waitcnt vmcnt(8)
    v_max3_u32 v2, v192, v193, v194
    v_max3_u32 v2, v2, v195, v196
    v_max3_u32 v2, v2, v197, v198
    v_max_u32 v2, v2, v199
    v_cmp_eq_u32_e64 vcc, -1, v2
    s_nop 0
    s_cbranch_vccnz B_o_r0
B_o_k0:
    s_barrier
    s_waitcnt lgkmcnt(15)
    v_mfma_f32_16x16x32_bf16 v[32:35], v[48:51], v[192:195], 0
    global_load_dwordx4 v[232:235], v103, s[72:73] offset:0 sc1
    v_mfma_f32_16x16x32_bf16 v[36:39], v[52:55], v[192:195], 0
    v_mfma_f32_16x16x32_bf16 v[40:43], v[56:59], v[192:195], 0
    v_mfma_f32_16x16x32_bf16 v[44:47], v[60:63], v[192:195], 0
    v_mfma_f32_16x16x32_bf16 v[32:35], v[64:67], v[196:199], v[32:35]
    ds_read_b64_tr_b16 v[48:49], v26 offset:16384
    global_load_dwordx4 v[236:239], v103, s[72:73] offset:2048 sc1
    v_mfma_f32_16x16x32_bf16 v[36:39], v[68:71], v[196:199], v[36:39]
    ds_read_b64_tr_b16 v[50:51], v26 offset:16896
    ds_read_b64_tr_b16 v[52:53], v27 offset:16384
    v_mfma_f32_16x16x32_bf16 v[40:43], v[72:75], v[196:199], v[40:43]
    ds_read_b64_tr_b16 v[54:55], v27 offset:16896
    v_mfma_f32_16x16x32_bf16 v[44:47], v[76:79], v[196:199], v[44:47]
    ds_read_b64_tr_b16 v[56:57], v28 offset:16384
    ds_read_b64_tr_b16 v[58:59], v28 offset:16896
    s_waitcnt vmcnt(8)
    v_max3_u32 v2, v200, v201, v202
    v_max3_u32 v2, v2, v203, v204
    v_max3_u32 v2, v2, v205, v206
    v_max_u32 v2, v2, v207
    v_cmp_eq_u32_e64 vcc, -1, v2
    s_nop 0
    s_cbranch_vccnz B_o_r2
B_o_k2:
    v_mfma_f32_16x16x32_bf16 v[32:35], v[112:115], v[200:203], v[32:35]
    ds_read_b64_tr_b16 v[60:61], v29 offset:16384
    global_load_dwordx4 v[240:243], v103, s[74:75] offset:-4096 sc1
    v_mfma_f32_16x16x32_bf16 v[36:39], v[116:119], v[200:203], v[36:39]
    ds_read_b64_tr_b16 v[62:63], v29 offset:16896
    ds_read_b64_tr_b16 v[64:65], v26 offset:20480
    v_mfma_f32_16x16x32_bf16 v[40:43], v[120:123], v[200:203], v[40:43]
    ds_read_b64_tr_b16 v[66:67], v26 offset:20992
    v_mfma_f32_16x16x32_bf16 v[44:47], v[124:127], v[200:203], v[44:47]
    ds_read_b64_tr_b16 v[68:69], v27 offset:20480
    ds_read_b64_tr_b16 v[70:71], v27 offset:20992
    v_mfma_f32_16x16x32_bf16 v[32:35], v[128:131], v[204:207], v[32:35]
    ds_read_b64_tr_b16 v[72:73], v28 offset:20480
    global_load_dwordx4 v[244:247], v103, s[74:75] offset:-2048 sc1
    v_mfma_f32_16x16x32_bf16 v[36:39], v[132:135], v[204:207], v[36:39]
    ds_read_b64_tr_b16 v[74:75], v28 offset:20992
    ds_read_b64_tr_b16 v[76:77], v29 offset:20480
    v_mfma_f32_16x16x32_bf16 v[40:43], v[136:139], v[204:207], v[40:43]
    ds_read_b64_tr_b16 v[78:79], v29 offset:20992
    v_mfma_f32_16x16x32_bf16 v[44:47], v[140:143], v[204:207], v[44:47]
    ds_read_b64_tr_b16 v[112:113], v26 offset:24576
    ds_read_b64_tr_b16 v[114:115], v26 offset:25088
    s_waitcnt vmcnt(8)
    v_max3_u32 v2, v208, v209, v210
    v_max3_u32 v2, v2, v211, v212
    v_max3_u32 v2, v2, v213, v214
    v_max_u32 v2, v2, v215
    v_cmp_eq_u32_e64 vcc, -1, v2
    s_nop 0
    s_cbranch_vccnz B_o_r4
B_o_k4:
    v_mfma_f32_16x16x32_bf16 v[32:35], v[144:147], v[208:211], v[32:35]
    ds_read_b64_tr_b16 v[116:117], v27 offset:24576
    global_load_dwordx4 v[248:251], v103, s[74:75] offset:0 sc1
    v_mfma_f32_16x16x32_bf16 v[36:39], v[148:151], v[208:211], v[36:39]
    ds_read_b64_tr_b16 v[118:119], v27 offset:25088
    ds_read_b64_tr_b16 v[120:121], v28 offset:24576
    v_mfma_f32_16x16x32_bf16 v[40:43], v[152:155], v[208:211], v[40:43]
    ds_read_b64_tr_b16 v[122:123], v28 offset:25088
    v_mfma_f32_16x16x32_bf16 v[44:47], v[156:159], v[208:211], v[44:47]
    ds_read_b64_tr_b16 v[124:125], v29 offset:24576
    ds_read_b64_tr_b16 v[126:127], v29 offset:25088
    v_mfma_f32_16x16x32_bf16 v[32:35], v[160:163], v[212:215], v[32:35]
    ds_read_b64_tr_b16 v[128:129], v26 offset:28672
    global_load_dwordx4 v[252:255], v103, s[74:75] offset:2048 sc1
    v_mfma_f32_16x16x32_bf16 v[36:39], v[164:167], v[212:215], v[36:39]
    ds_read_b64_tr_b16 v[130:131], v26 offset:29184
    ds_read_b64_tr_b16 v[132:133], v27 offset:28672
    v_mfma_f32_16x16x32_bf16 v[40:43], v[168:171], v[212:215], v[40:43]
    ds_read_b64_tr_b16 v[134:135], v27 offset:29184
    v_mfma_f32_16x16x32_bf16 v[44:47], v[172:175], v[212:215], v[44:47]
    ds_read_b64_tr_b16 v[136:137], v28 offset:28672
    ds_read_b64_tr_b16 v[138:139], v28 offset:29184
    s_waitcnt vmcnt(8)
    v_max3_u32 v2, v216, v217, v218
    v_max3_u32 v2, v2, v219, v220
    v_max3_u32 v2, v2, v221, v222
    v_max_u32 v2, v2, v223
    v_cmp_eq_u32 vcc, -1, v2
    s_nop 0
    s_cbranch_vccnz B_o_r6
B_o_k6:
    s_waitcnt lgkmcnt(15)
    v_mfma_f32_16x16x32_bf16 v[32:35], v[176:179], v[216:219], v[32:35]
    ds_read_b64_tr_b16 v[140:141], v29 offset:28672
    v_mfma_f32_16x16x32_bf16 v[36:39], v[180:183], v[216:219], v[36:39]
    ds_read_b64_tr_b16 v[142:143], v29 offset:29184
    ds_read_b64_tr_b16 v[144:145], v12 offset:0
    v_mfma_f32_16x16x32_bf16 v[40:43], v[184:187], v[216:219], v[40:43]
    ds_read_b64_tr_b16 v[146:147], v12 offset:512
    v_mfma_f32_16x16x32_bf16 v[44:47], v[188:191], v[216:219], v[44:47]
    ds_read_b64_tr_b16 v[148:149], v13 offset:0
    ds_read_b64_tr_b16 v[150:151], v13 offset:512
    v_mfma_f32_16x16x32_bf16 v[32:35], v[80:83], v[220:223], v[32:35]
    ds_read_b64_tr_b16 v[152:153], v14 offset:0
    v_mfma_f32_16x16x32_bf16 v[36:39], v[84:87], v[220:223], v[36:39]
    ds_read_b64_tr_b16 v[154:155], v14 offset:512
    ds_read_b64_tr_b16 v[156:157], v15 offset:0
    v_mfma_f32_16x16x32_bf16 v[40:43], v[88:91], v[220:223], v[40:43]
    ds_read_b64_tr_b16 v[158:159], v15 offset:512
    v_mfma_f32_16x16x32_bf16 v[44:47], v[92:95], v[220:223], v[44:47]
    ds_read_b64_tr_b16 v[160:161], v12 offset:4096
    ds_read_b64_tr_b16 v[162:163], v12 offset:4608
    s_waitcnt vmcnt(6)
    v_max3_u32 v2, v224, v225, v226
    v_max3_u32 v2, v2, v227, v228
    v_max3_u32 v2, v2, v229, v230
    v_max_u32 v2, v2, v231
    v_cmp_eq_u32_e64 vcc, -1, v2
    s_nop 0
    s_cbranch_vccnz B_o_r8
B_o_k8:
    v_mfma_f32_16x16x32_bf16 v[32:35], v[48:51], v[224:227], v[32:35]
    ds_read_b64_tr_b16 v[164:165], v13 offset:4096
    v_mfma_f32_16x16x32_bf16 v[36:39], v[52:55], v[224:227], v[36:39]
    ds_read_b64_tr_b16 v[166:167], v13 offset:4608
    ds_read_b64_tr_b16 v[168:169], v14 offset:4096
    v_mfma_f32_16x16x32_bf16 v[40:43], v[56:59], v[224:227], v[40:43]
    ds_read_b64_tr_b16 v[170:171], v14 offset:4608
    v_mfma_f32_16x16x32_bf16 v[44:47], v[60:63], v[224:227], v[44:47]
    ds_read_b64_tr_b16 v[172:173], v15 offset:4096
    ds_read_b64_tr_b16 v[174:175], v15 offset:4608
    v_mfma_f32_16x16x32_bf16 v[32:35], v[64:67], v[228:231], v[32:35]
    ds_read_b64_tr_b16 v[176:177], v12 offset:8192
    v_mfma_f32_16x16x32_bf16 v[36:39], v[68:71], v[228:231], v[36:39]
    ds_read_b64_tr_b16 v[178:179], v12 offset:8704
    ds_read_b64_tr_b16 v[180:181], v13 offset:8192
    v_mfma_f32_16x16x32_bf16 v[40:43], v[72:75], v[228:231], v[40:43]
    ds_read_b64_tr_b16 v[182:183], v13 offset:8704
    s_waitcnt lgkmcnt(15)
    v_mfma_f32_16x16x32_bf16 v[44:47], v[76:79], v[228:231], v[44:47]
    ds_read_b64_tr_b16 v[184:185], v14 offset:8192
    ds_read_b64_tr_b16 v[186:187], v14 offset:8704
    s_waitcnt vmcnt(4)
    v_max3_u32 v2, v232, v233, v234
    v_max3_u32 v2, v2, v235, v236
    v_max3_u32 v2, v2, v237, v238
    v_max_u32 v2, v2, v239
    v_cmp_eq_u32 vcc, -1, v2
    s_nop 0
    s_cbranch_vccnz B_o_r10
B_o_k10:
    v_mfma_f32_16x16x32_bf16 v[32:35], v[112:115], v[232:235], v[32:35]
    ds_read_b64_tr_b16 v[188:189], v15 offset:8192
    v_mfma_f32_16x16x32_bf16 v[36:39], v[116:119], v[232:235], v[36:39]
    ds_read_b64_tr_b16 v[190:191], v15 offset:8704
    ds_read_b64_tr_b16 v[80:81], v12 offset:12288
    v_mfma_f32_16x16x32_bf16 v[40:43], v[120:123], v[232:235], v[40:43]
    ds_read_b64_tr_b16 v[82:83], v12 offset:12800
    v_mfma_f32_16x16x32_bf16 v[44:47], v[124:127], v[232:235], v[44:47]
    ds_read_b64_tr_b16 v[84:85], v13 offset:12288
    ds_read_b64_tr_b16 v[86:87], v13 offset:12800
    v_mfma_f32_16x16x32_bf16 v[32:35], v[128:131], v[236:239], v[32:35]
    ds_read_b64_tr_b16 v[88:89], v14 offset:12288
    v_mfma_f32_16x16x32_bf16 v[36:39], v[132:135], v[236:239], v[36:39]
    ds_read_b64_tr_b16 v[90:91], v14 offset:12800
    ds_read_b64_tr_b16 v[92:93], v15 offset:12288
    v_mfma_f32_16x16x32_bf16 v[40:43], v[136:139], v[236:239], v[40:43]
    ds_read_b64_tr_b16 v[94:95], v15 offset:12800
    v_mfma_f32_16x16x32_bf16 v[44:47], v[140:143], v[236:239], v[44:47]
    s_waitcnt vmcnt(2)
    v_max3_u32 v2, v240, v241, v242
    v_max3_u32 v2, v2, v243, v244
    v_max3_u32 v2, v2, v245, v246
    v_max_u32 v2, v2, v247
    v_cmp_eq_u32_e64 vcc, -1, v2
    s_nop 0
    s_cbranch_vccnz B_o_r12
B_o_k12:
    v_mfma_f32_16x16x32_bf16 v[32:35], v[144:147], v[240:243], v[32:35]
    v_mfma_f32_16x16x32_bf16 v[36:39], v[148:151], v[240:243], v[36:39]
    s_waitcnt lgkmcnt(15)
    s_nop 0
    v_mfma_f32_16x16x32_bf16 v[40:43], v[152:155], v[240:243], v[40:43]
    v_mfma_f32_16x16x32_bf16 v[44:47], v[156:159], v[240:243], v[44:47]
    v_mfma_f32_16x16x32_bf16 v[32:35], v[160:163], v[244:247], v[32:35]
    v_mfma_f32_16x16x32_bf16 v[36:39], v[164:167], v[244:247], v[36:39]
    v_mfma_f32_16x16x32_bf16 v[40:43], v[168:171], v[244:247], v[40:43]
    v_mfma_f32_16x16x32_bf16 v[44:47], v[172:175], v[244:247], v[44:47]
    s_waitcnt vmcnt(0)
    v_max3_u32 v2, v248, v249, v250
    v_max3_u32 v2, v2, v251, v252
    v_max3_u32 v2, v2, v253, v254
    v_max_u32 v2, v2, v255
    v_cmp_eq_u32 vcc, -1, v2
    s_nop 0
    s_cbranch_vccnz B_o_r14
B_o_k14:
    s_waitcnt lgkmcnt(14)
    v_mfma_f32_16x16x32_bf16 v[32:35], v[176:179], v[248:251], v[32:35]
    s_waitcnt lgkmcnt(12)
    v_mfma_f32_16x16x32_bf16 v[36:39], v[180:183], v[248:251], v[36:39]
    s_waitcnt lgkmcnt(10)
    v_mfma_f32_16x16x32_bf16 v[40:43], v[184:187], v[248:251], v[40:43]
    s_waitcnt lgkmcnt(8)
    v_mfma_f32_16x16x32_bf16 v[44:47], v[188:191], v[248:251], v[44:47]
    s_waitcnt lgkmcnt(6)
    v_mfma_f32_16x16x32_bf16 v[32:35], v[80:83], v[252:255], v[32:35]
    s_waitcnt lgkmcnt(4)
    v_mfma_f32_16x16x32_bf16 v[36:39], v[84:87], v[252:255], v[36:39]
    s_waitcnt lgkmcnt(2)
    v_mfma_f32_16x16x32_bf16 v[40:43], v[88:91], v[252:255], v[40:43]
    s_waitcnt lgkmcnt(0)
    v_mfma_f32_16x16x32_bf16 v[44:47], v[92:95], v[252:255], v[44:47]
    v_mov_b32 v2, 7356416
    s_or_b32 s41, s2, s40
    s_cmp_lg_u32 s41, 0
    s_cbranch_scc1 B_noep
    s_mov_b64 exec, 1
    global_store_dword v2, v5, s[34:35] sc1
    s_mov_b64 exec, -1
B_noep:
    v_cvt_pk_bf16_f32 v48, v32, v33
    v_cvt_pk_bf16_f32 v49, v34, v35
    ds_write_b64 v104, v[48:49] offset:0
    v_cvt_pk_bf16_f32 v50, v36, v37
    v_cvt_pk_bf16_f32 v51, v38, v39
    ds_write_b64 v104, v[50:51] offset:32
    v_cvt_pk_bf16_f32 v52, v40, v41
    v_cvt_pk_bf16_f32 v53, v42, v43
    ds_write_b64 v104, v[52:53] offset:64
    v_cvt_pk_bf16_f32 v54, v44, v45
    v_cvt_pk_bf16_f32 v55, v46, v47
    ds_write_b64 v104, v[54:55] offset:96
    s_waitcnt lgkmcnt(0)
    ds_read_b128 v[56:59], v105
    ds_read_b128 v[60:63], v105 offset:1152
    s_waitcnt lgkmcnt(1)
    global_store_dwordx4 v106, v[56:59], s[6:7] nt
    s_waitcnt lgkmcnt(0)
    global_store_dwordx4 v106, v[60:63], s[8:9] nt
    s_endpgm
B_kv_r:
    global_load_dwordx3 v[128:130], v20, s[56:57] offset:-3072 sc1
    global_load_dwordx3 v[132:134], v20, s[56:57] offset:0 sc1
    global_load_dwordx3 v[136:138], v21, s[56:57] offset:-3072 sc1
    global_load_dwordx3 v[140:142], v21, s[56:57] offset:0 sc1
    global_load_dwordx3 v[144:146], v20, s[58:59] offset:-3072 sc1
    global_load_dwordx3 v[148:150], v20, s[58:59] offset:0 sc1
    global_load_dwordx3 v[152:154], v21, s[58:59] offset:-3072 sc1
    global_load_dwordx3 v[156:158], v21, s[58:59] offset:0 sc1
    global_load_dwordx3 v[160:162], v20, s[60:61] offset:-3072 sc1
    global_load_dwordx3 v[164:166], v20, s[60:61] offset:0 sc1
    global_load_dwordx3 v[168:170], v21, s[60:61] offset:-3072 sc1
    global_load_dwordx3 v[172:174], v21, s[60:61] offset:0 sc1
    global_load_dwordx3 v[176:178], v20, s[62:63] offset:-3072 sc1
    global_load_dwordx3 v[180:182], v20, s[62:63] offset:0 sc1
    global_load_dwordx3 v[184:186], v21, s[62:63] offset:-3072 sc1
    global_load_dwordx3 v[188:190], v21, s[62:63] offset:0 sc1
    s_add_u32 s45, s45, 1
    s_cmp_gt_u32 s45, 400000
    s_waitcnt vmcnt(0)
    s_cbranch_scc1 B_kv_k
    v_mfma_f32_16x16x32_bf16 v[48:51], v[112:115], v[128:131], 0
    v_and_b32 v52, 0xffff0000, v130
    v_xor_b32 v53, v5, v130
    v_mfma_f32_16x16x32_bf16 v[48:51], v[112:115], v[132:135], v[48:51]
    v_and_b32 v56, 0xffff0000, v134
    v_bitop3_b32 v53, v5, v134, v53 bitop3:0xbe
    v_add_f32_e64 v52, v52, v56
    v_mfma_f32_16x16x32_bf16 v[48:51], v[112:115], v[136:139], v[48:51]
    v_and_b32 v56, 0xffff0000, v138
    v_bitop3_b32 v53, v5, v138, v53 bitop3:0xbe
    v_add_f32_e64 v52, v52, v56
    v_mfma_f32_16x16x32_bf16 v[48:51], v[112:115], v[140:143], v[48:51]
    v_and_b32 v56, 0xffff0000, v142
    v_bitop3_b32 v53, v5, v142, v53 bitop3:0xbe
    v_add_f32_e64 v52, v52, v56
    v_mfma_f32_16x16x32_bf16 v[48:51], v[112:115], v[144:147], v[48:51]
    v_and_b32 v56, 0xffff0000, v146
    v_bitop3_b32 v53, v5, v146, v53 bitop3:0xbe
    v_add_f32_e64 v52, v52, v56
    v_mfma_f32_16x16x32_bf16 v[48:51], v[112:115], v[148:151], v[48:51]
    v_and_b32 v56, 0xffff0000, v150
    v_bitop3_b32 v53, v5, v150, v53 bitop3:0xbe
    v_add_f32_e64 v52, v52, v56
    v_mfma_f32_16x16x32_bf16 v[48:51], v[112:115], v[152:155], v[48:51]
    v_and_b32 v56, 0xffff0000, v154
    v_bitop3_b32 v53, v5, v154, v53 bitop3:0xbe
    v_add_f32_e64 v52, v52, v56
    v_mfma_f32_16x16x32_bf16 v[48:51], v[112:115], v[156:159], v[48:51]
    v_and_b32 v56, 0xffff0000, v158
    v_bitop3_b32 v53, v5, v158, v53 bitop3:0xbe
    v_add_f32_e64 v52, v52, v56
    v_mfma_f32_16x16x32_bf16 v[48:51], v[112:115], v[160:163], v[48:51]
    v_and_b32 v56, 0xffff0000, v162
    v_bitop3_b32 v53, v5, v162, v53 bitop3:0xbe
    v_add_f32_e64 v52, v52, v56
    v_mfma_f32_16x16x32_bf16 v[48:51], v[112:115], v[164:167], v[48:51]
    v_and_b32 v56, 0xffff0000, v166
    v_bitop3_b32 v53, v5, v166, v53 bitop3:0xbe
    v_add_f32_e64 v52, v52, v56
    v_mfma_f32_16x16x32_bf16 v[48:51], v[112:115], v[168:171], v[48:51]
    v_and_b32 v56, 0xffff0000, v170
    v_bitop3_b32 v53, v5, v170, v53 bitop3:0xbe
    v_add_f32_e64 v52, v52, v56
    v_mfma_f32_16x16x32_bf16 v[48:51], v[112:115], v[172:175], v[48:51]
    v_and_b32 v56, 0xffff0000, v174
    v_bitop3_b32 v53, v5, v174, v53 bitop3:0xbe
    v_add_f32_e64 v52, v52, v56
    v_mfma_f32_16x16x32_bf16 v[48:51], v[112:115], v[176:179], v[48:51]
    v_and_b32 v56, 0xffff0000, v178
    v_bitop3_b32 v53, v5, v178, v53 bitop3:0xbe
    v_add_f32_e64 v52, v52, v56
    v_mfma_f32_16x16x32_bf16 v[48:51], v[112:115], v[180:183], v[48:51]
    v_and_b32 v56, 0xffff0000, v182
    v_bitop3_b32 v53, v5, v182, v53 bitop3:0xbe
    v_add_f32_e64 v52, v52, v56
    v_mfma_f32_16x16x32_bf16 v[48:51], v[112:115], v[184:187], v[48:51]
    v_and_b32 v56, 0xffff0000, v186
    v_bitop3_b32 v53, v5, v186, v53 bitop3:0xbe
    v_add_f32_e64 v52, v52, v56
    v_mfma_f32_16x16x32_bf16 v[48:51], v[112:115], v[188:191], v[48:51]
    v_and_b32 v56, 0xffff0000, v190
    v_bitop3_b32 v53, v5, v190, v53 bitop3:0xbe
    v_add_f32_e64 v52, v52, v56
    v_and_b32 v53, 0xffff, v53
    v_cmp_ne_u32_e64 vcc, 0, v53
    s_nop 7
    s_cbranch_vccnz B_kv_r
    s_branch B_kv_k
B_fc_r:
    s_sleep 1
    global_load_dword v110, v109, s[34:35] sc1
    s_add_u32 s45, s45, 1
    s_cmp_gt_u32 s45, 400000
    s_waitcnt vmcnt(0)
    s_cbranch_scc1 B_fc_k
    v_cmp_ne_u32_e64 vcc, s44, v110
    s_nop 1
    s_cbranch_vccnz B_fc_r
    s_branch B_fc_k
B_o_r0:
    global_load_dwordx4 v[192:195], v103, s[68:69] offset:-4096 sc1
    global_load_dwordx4 v[196:199], v103, s[68:69] offset:-2048 sc1
    global_load_dwordx4 v[200:203], v103, s[68:69] offset:0 sc1
    global_load_dwordx4 v[204:207], v103, s[68:69] offset:2048 sc1
    global_load_dwordx4 v[208:211], v103, s[70:71] offset:-4096 sc1
    global_load_dwordx4 v[212:215], v103, s[70:71] offset:-2048 sc1
    global_load_dwordx4 v[216:219], v103, s[70:71] offset:0 sc1
    global_load_dwordx4 v[220:223], v103, s[70:71] offset:2048 sc1
    global_load_dwordx4 v[224:227], v103, s[72:73] offset:-4096 sc1
    global_load_dwordx4 v[228:231], v103, s[72:73] offset:-2048 sc1
    s_add_u32 s45, s45, 1
    s_cmp_gt_u32 s45, 400000
    s_waitcnt vmcnt(0)
    s_cbranch_scc1 B_o_k0
    v_max3_u32 v2, v192, v193, v194
    v_max3_u32 v2, v2, v195, v196
    v_max3_u32 v2, v2, v197, v198
    v_max_u32 v2, v2, v199
    v_cmp_eq_u32 vcc, -1, v2
    s_nop 1
    s_cbranch_vccnz B_o_r0
    s_branch B_o_k0
B_o_r2:
    global_load_dwordx4 v[200:203], v103, s[68:69] offset:0 sc1
    global_load_dwordx4 v[204:207], v103, s[68:69] offset:2048 sc1
    global_load_dwordx4 v[208:211], v103, s[70:71] offset:-4096 sc1
    global_load_dwordx4 v[212:215], v103, s[70:71] offset:-2048 sc1
    global_load_dwordx4 v[216:219], v103, s[70:71] offset:0 sc1
    global_load_dwordx4 v[220:223], v103, s[70:71] offset:2048 sc1
    global_load_dwordx4 v[224:227], v103, s[72:73] offset:-4096 sc1
    global_load_dwordx4 v[228:231], v103, s[72:73] offset:-2048 sc1
    global_load_dwordx4 v[232:235], v103, s[72:73] offset:0 sc1
    global_load_dwordx4 v[236:239], v103, s[72:73] offset:2048 sc1
    s_add_u32 s45, s45, 1
    s_cmp_gt_u32 s45, 400000
    s_waitcnt vmcnt(0)
    s_cbranch_scc1 B_o_k2
    v_max3_u32 v2, v200, v201, v202
    v_max3_u32 v2, v2, v203, v204
    v_max3_u32 v2, v2, v205, v206
    v_max_u32 v2, v2, v207
    v_cmp_eq_u32 vcc, -1, v2
    s_nop 1
    s_cbranch_vccnz B_o_r2
    s_branch B_o_k2
B_o_r4:
    global_load_dwordx4 v[208:211], v103, s[70:71] offset:-4096 sc1
    global_load_dwordx4 v[212:215], v103, s[70:71] offset:-2048 sc1
    global_load_dwordx4 v[216:219], v103, s[70:71] offset:0 sc1
    global_load_dwordx4 v[220:223], v103, s[70:71] offset:2048 sc1
    global_load_dwordx4 v[224:227], v103, s[72:73] offset:-4096 sc1
    global_load_dwordx4 v[228:231], v103, s[72:73] offset:-2048 sc1
    global_load_dwordx4 v[232:235], v103, s[72:73] offset:0 sc1
    global_load_dwordx4 v[236:239], v103, s[72:73] offset:2048 sc1
    global_load_dwordx4 v[240:243], v103, s[74:75] offset:-4096 sc1
    global_load_dwordx4 v[244:247], v103, s[74:75] offset:-2048 sc1
    s_add_u32 s45, s45, 1
    s_cmp_gt_u32 s45, 400000
    s_waitcnt vmcnt(0)
    s_cbranch_scc1 B_o_k4
    v_max3_u32 v2, v208, v209, v210
    v_max3_u32 v2, v2, v211, v212
    v_max3_u32 v2, v2, v213, v214
    v_max_u32 v2, v2, v215
    v_cmp_eq_u32 vcc, -1, v2
    s_nop 1
    s_cbranch_vccnz B_o_r4
    s_branch B_o_k4
B_o_r6:
    global_load_dwordx4 v[216:219], v103, s[70:71] offset:0 sc1
    global_load_dwordx4 v[220:223], v103, s[70:71] offset:2048 sc1
    global_load_dwordx4 v[224:227], v103, s[72:73] offset:-4096 sc1
    global_load_dwordx4 v[228:231], v103, s[72:73] offset:-2048 sc1
    global_load_dwordx4 v[232:235], v103, s[72:73] offset:0 sc1
    global_load_dwordx4 v[236:239], v103, s[72:73] offset:2048 sc1
    global_load_dwordx4 v[240:243], v103, s[74:75] offset:-4096 sc1
    global_load_dwordx4 v[244:247], v103, s[74:75] offset:-2048 sc1
    global_load_dwordx4 v[248:251], v103, s[74:75] offset:0 sc1
    global_load_dwordx4 v[252:255], v103, s[74:75] offset:2048 sc1
    s_add_u32 s45, s45, 1
    s_cmp_gt_u32 s45, 400000
    s_waitcnt vmcnt(0)
    s_cbranch_scc1 B_o_k6
    v_max3_u32 v2, v216, v217, v218
    v_max3_u32 v2, v2, v219, v220
    v_max3_u32 v2, v2, v221, v222
    v_max_u32 v2, v2, v223
    v_cmp_eq_u32 vcc, -1, v2
    s_nop 1
    s_cbranch_vccnz B_o_r6
    s_branch B_o_k6
B_o_r8:
    global_load_dwordx4 v[224:227], v103, s[72:73] offset:-4096 sc1
    global_load_dwordx4 v[228:231], v103, s[72:73] offset:-2048 sc1
    global_load_dwordx4 v[232:235], v103, s[72:73] offset:0 sc1
    global_load_dwordx4 v[236:239], v103, s[72:73] offset:2048 sc1
    global_load_dwordx4 v[240:243], v103, s[74:75] offset:-4096 sc1
    global_load_dwordx4 v[244:247], v103, s[74:75] offset:-2048 sc1
    global_load_dwordx4 v[248:251], v103, s[74:75] offset:0 sc1
    global_load_dwordx4 v[252:255], v103, s[74:75] offset:2048 sc1
    s_add_u32 s45, s45, 1
    s_cmp_gt_u32 s45, 400000
    s_waitcnt vmcnt(0)
    s_cbranch_scc1 B_o_k8
    v_max3_u32 v2, v224, v225, v226
    v_max3_u32 v2, v2, v227, v228
    v_max3_u32 v2, v2, v229, v230
    v_max_u32 v2, v2, v231
    v_cmp_eq_u32 vcc, -1, v2
    s_nop 1
    s_cbranch_vccnz B_o_r8
    s_branch B_o_k8
B_o_r10:
    global_load_dwordx4 v[232:235], v103, s[72:73] offset:0 sc1
    global_load_dwordx4 v[236:239], v103, s[72:73] offset:2048 sc1
    global_load_dwordx4 v[240:243], v103, s[74:75] offset:-4096 sc1
    global_load_dwordx4 v[244:247], v103, s[74:75] offset:-2048 sc1
    global_load_dwordx4 v[248:251], v103, s[74:75] offset:0 sc1
    global_load_dwordx4 v[252:255], v103, s[74:75] offset:2048 sc1
    s_add_u32 s45, s45, 1
    s_cmp_gt_u32 s45, 400000
    s_waitcnt vmcnt(0)
    s_cbranch_scc1 B_o_k10
    v_max3_u32 v2, v232, v233, v234
    v_max3_u32 v2, v2, v235, v236
    v_max3_u32 v2, v2, v237, v238
    v_max_u32 v2, v2, v239
    v_cmp_eq_u32 vcc, -1, v2
    s_nop 1
    s_cbranch_vccnz B_o_r10
    s_branch B_o_k10
B_o_r12:
    global_load_dwordx4 v[240:243], v103, s[74:75] offset:-4096 sc1
    global_load_dwordx4 v[244:247], v103, s[74:75] offset:-2048 sc1
    global_load_dwordx4 v[248:251], v103, s[74:75] offset:0 sc1
    global_load_dwordx4 v[252:255], v103, s[74:75] offset:2048 sc1
    s_add_u32 s45, s45, 1
    s_cmp_gt_u32 s45, 400000
    s_waitcnt vmcnt(0)
    s_cbranch_scc1 B_o_k12
    v_max3_u32 v2, v240, v241, v242
    v_max3_u32 v2, v2, v243, v244
    v_max3_u32 v2, v2, v245, v246
    v_max_u32 v2, v2, v247
    v_cmp_eq_u32 vcc, -1, v2
    s_nop 1
    s_cbranch_vccnz B_o_r12
    s_branch B_o_k12
B_o_r14:
    global_load_dwordx4 v[248:251], v103, s[74:75] offset:0 sc1
    global_load_dwordx4 v[252:255], v103, s[74:75] offset:2048 sc1
    s_add_u32 s45, s45, 1
    s_cmp_gt_u32 s45, 400000
    s_waitcnt vmcnt(0)
    s_cbranch_scc1 B_o_k14
    v_max3_u32 v2, v248, v249, v250
    v_max3_u32 v2, v2, v251, v252
    v_max3_u32 v2, v2, v253, v254
    v_max_u32 v2, v2, v255
    v_cmp_eq_u32_e64 vcc, -1, v2
    s_nop 1
    s_cbranch_vccnz B_o_r14
    s_branch B_o_k14
A_cont:
    s_lshl_b32 s42, s40, 4
    s_lshr_b32 s47, s47, s42
    s_lshl_b32 s47, s47, 16
    s_lshr_b32 s48, s48, s42
    s_lshl_b32 s48, s48, 16
    s_mov_b32 s52, 0x3fb8aa3b
    s_mov_b32 s53, 0x32a57060
    s_mov_b32 s62, 0x3f317218
    v_mov_b32 v9, s47
    v_mul_f32 v7, s52, v9
    v_fma_f32 v8, v9, s52, -v7
    v_fma_f32 v8, v9, s53, v8
    v_exp_f32 v7, v7
    v_mul_f32 v8, s62, v8
    v_fma_f32 v7, v7, v8, v7
    v_cvt_pk_bf16_f32 v7, v7, v7
    v_lshlrev_b32 v20, 16, v7
    s_waitcnt vmcnt(5)
    v_lshlrev_b32 v32, 16, v32
    s_waitcnt vmcnt(4)
    v_lshlrev_b32 v33, 16, v33
    s_waitcnt vmcnt(3)
    v_lshlrev_b32 v34, 16, v34
    s_waitcnt vmcnt(2)
    v_lshlrev_b32 v35, 16, v35
    s_waitcnt vmcnt(1)
    v_lshlrev_b32 v36, 16, v36
    s_waitcnt vmcnt(0)
    v_lshlrev_b32_e64 v37, 16, v37
    global_load_dwordx4 v[12:15], v252, s[4:5]
    global_load_dwordx4 v[16:19], v252, s[4:5] offset:1024
    v_mul_f32 v21, v20, v32
    v_mul_f32 v22, v20, v33
    v_mul_f32 v34, v20, v34
    v_mul_f32 v35, v20, v35
    v_mul_f32 v21, s52, v21
    v_mul_f32 v22, 0.15915494, v22
    v_exp_f32 v23, v21
    v_fract_f32 v46, v22
    v_mul_f32 v24, 0x41000000, v21
    v_mul_f32 v47, 0x41000000, v22
    v_exp_f32 v24, v24
    v_fract_f32 v47, v47
    v_mul_f32 v25, 0x43800000, v21
    v_mul_f32 v48, 0x43800000, v22
    v_exp_f32 v25, v25
    v_fract_f32 v48, v48
    v_cos_f32 v40, v46
    v_sin_f32 v41, v46
    v_cos_f32 v42, v47
    v_sin_f32 v43, v47
    v_cos_f32 v44, v48
    v_sin_f32 v45, v48
    v_mul_f32 v40, v23, v40
    v_mul_f32 v41, v23, v41
    v_mul_f32_e64 v42, v24, v42
    v_mul_f32_e64 v43, -v24, v43
    v_mul_f32 v44, v25, v44
    v_mul_f32 v45, v25, v45
    v_cvt_pk_bf16_f32 v144, 1.0, v42
    v_cvt_pk_bf16_f32 v160, 0, v43
    v_pk_mul_f32 v[26:27], v[36:37], v[34:35] op_sel:[1,1] op_sel_hi:[1,0] neg_lo:[0,1]
    v_pk_fma_f32 v[50:51], v[36:37], v[34:35], v[26:27] op_sel:[0,0,0] op_sel_hi:[0,1,1]
    v_pk_mul_f32 v[28:29], v[42:43], v[42:43] op_sel:[1,1] op_sel_hi:[1,0] neg_lo:[0,1]
    v_pk_fma_f32 v[30:31], v[42:43], v[42:43], v[28:29] op_sel:[0,0,0] op_sel_hi:[0,1,1]
    v_pk_mul_f32 v[26:27], v[50:51], v[40:41] op_sel:[1,1] op_sel_hi:[1,0] neg_lo:[0,1]
    v_pk_fma_f32 v[52:53], v[50:51], v[40:41], v[26:27] op_sel:[0,0,0] op_sel_hi:[0,1,1]
    v_pk_mul_f32 v[28:29], v[30:31], v[42:43] op_sel:[1,1] op_sel_hi:[1,0] neg_lo:[0,1]
    v_pk_fma_f32 v[38:39], v[30:31], v[42:43], v[28:29] op_sel:[0,0,0] op_sel_hi:[0,1,1]
    v_cvt_pk_bf16_f32 v112, v50, v52
    v_cvt_pk_bf16_f32 v128, v51, v53
    v_cvt_pk_bf16_f32 v145, v30, v38
    v_cvt_pk_bf16_f32 v161, v31, v39
    v_pk_mul_f32 v[26:27], v[52:53], v[40:41] op_sel:[1,1] op_sel_hi:[1,0] neg_lo:[0,1]
    v_pk_fma_f32 v[54:55], v[52:53], v[40:41], v[26:27] op_sel:[0,0,0] op_sel_hi:[0,1,1]
    v_pk_mul_f32 v[28:29], v[38:39], v[42:43] op_sel:[1,1] op_sel_hi:[1,0] neg_lo:[0,1]
    v_pk_fma_f32 v[30:31], v[38:39], v[42:43], v[28:29] op_sel:[0,0,0] op_sel_hi:[0,1,1]
    v_pk_mul_f32 v[26:27], v[54:55], v[40:41] op_sel:[1,1] op_sel_hi:[1,0] neg_lo:[0,1]
    v_pk_fma_f32 v[56:57], v[54:55], v[40:41], v[26:27] op_sel:[0,0,0] op_sel_hi:[0,1,1]
    v_pk_mul_f32 v[28:29], v[30:31], v[42:43] op_sel:[1,1] op_sel_hi:[1,0] neg_lo:[0,1]
    v_pk_fma_f32 v[38:39], v[30:31], v[42:43], v[28:29] op_sel:[0,0,0] op_sel_hi:[0,1,1]
    v_cvt_pk_bf16_f32 v113, v54, v56
    v_cvt_pk_bf16_f32 v129, v55, v57
    v_cvt_pk_bf16_f32 v146, v30, v38
    v_cvt_pk_bf16_f32 v162, v31, v39
    v_pk_mul_f32 v[26:27], v[56:57], v[40:41] op_sel:[1,1] op_sel_hi:[1,0] neg_lo:[0,1]
    v_pk_fma_f32 v[58:59], v[56:57], v[40:41], v[26:27] op_sel:[0,0,0] op_sel_hi:[0,1,1]
    v_pk_mul_f32 v[28:29], v[38:39], v[42:43] op_sel:[1,1] op_sel_hi:[1,0] neg_lo:[0,1]
    v_pk_fma_f32 v[30:31], v[38:39], v[42:43], v[28:29] op_sel:[0,0,0] op_sel_hi:[0,1,1]
    v_pk_mul_f32 v[26:27], v[58:59], v[40:41] op_sel:[1,1] op_sel_hi:[1,0] neg_lo:[0,1]
    v_pk_fma_f32 v[60:61], v[58:59], v[40:41], v[26:27] op_sel:[0,0,0] op_sel_hi:[0,1,1]
    v_pk_mul_f32 v[28:29], v[30:31], v[42:43] op_sel:[1,1] op_sel_hi:[1,0] neg_lo:[0,1]
    v_pk_fma_f32 v[38:39], v[30:31], v[42:43], v[28:29] op_sel:[0,0,0] op_sel_hi:[0,1,1]
    v_cvt_pk_bf16_f32 v116, v58, v60
    v_cvt_pk_bf16_f32 v132, v59, v61
    v_cvt_pk_bf16_f32 v147, v30, v38
    v_cvt_pk_bf16_f32 v163, v31, v39
    v_pk_mul_f32 v[26:27], v[60:61], v[40:41] op_sel:[1,1] op_sel_hi:[1,0] neg_lo:[0,1]
    v_pk_fma_f32 v[62:63], v[60:61], v[40:41], v[26:27] op_sel:[0,0,0] op_sel_hi:[0,1,1]
    v_pk_mul_f32 v[28:29], v[38:39], v[42:43] op_sel:[1,1] op_sel_hi:[1,0] neg_lo:[0,1]
    v_pk_fma_f32 v[30:31], v[38:39], v[42:43], v[28:29] op_sel:[0,0,0] op_sel_hi:[0,1,1]
    v_pk_mul_f32 v[26:27], v[50:51], v[44:45] op_sel:[1,1] op_sel_hi:[1,0] neg_lo:[0,1]
    v_pk_fma_f32 v[64:65], v[50:51], v[44:45], v[26:27] op_sel:[0,0,0] op_sel_hi:[0,1,1]
    v_pk_mul_f32 v[28:29], v[30:31], v[42:43] op_sel:[1,1] op_sel_hi:[1,0] neg_lo:[0,1]
    v_pk_fma_f32 v[38:39], v[30:31], v[42:43], v[28:29] op_sel:[0,0,0] op_sel_hi:[0,1,1]
    v_cvt_pk_bf16_f32 v148, v30, v38
    v_cvt_pk_bf16_f32 v164, v31, v39
    v_pk_mul_f32 v[26:27], v[54:55], v[44:45] op_sel:[1,1] op_sel_hi:[1,0] neg_lo:[0,1]
    v_pk_fma_f32 v[66:67], v[54:55], v[44:45], v[26:27] op_sel:[0,0,0] op_sel_hi:[0,1,1]
    v_pk_mul_f32 v[28:29], v[38:39], v[42:43] op_sel:[1,1] op_sel_hi:[1,0] neg_lo:[0,1]
    v_pk_fma_f32 v[30:31], v[38:39], v[42:43], v[28:29] op_sel:[0,0,0] op_sel_hi:[0,1,1]
    v_cvt_pk_bf16_f32 v114, v64, v66
    v_cvt_pk_bf16_f32 v130, v65, v67
    v_pk_mul_f32 v[26:27], v[58:59], v[44:45] op_sel:[1,1] op_sel_hi:[1,0] neg_lo:[0,1]
    v_pk_fma_f32 v[68:69], v[58:59], v[44:45], v[26:27] op_sel:[0,0,0] op_sel_hi:[0,1,1]
    v_pk_mul_f32 v[28:29], v[30:31], v[42:43] op_sel:[1,1] op_sel_hi:[1,0] neg_lo:[0,1]
    v_pk_fma_f32 v[38:39], v[30:31], v[42:43], v[28:29] op_sel:[0,0,0] op_sel_hi:[0,1,1]
    v_cvt_pk_bf16_f32 v149, v30, v38
    v_cvt_pk_bf16_f32 v165, v31, v39
    v_pk_mul_f32 v[26:27], v[62:63], v[44:45] op_sel:[1,1] op_sel_hi:[1,0] neg_lo:[0,1]
    v_pk_fma_f32 v[70:71], v[62:63], v[44:45], v[26:27] op_sel:[0,0,0] op_sel_hi:[0,1,1]
    v_pk_mul_f32 v[28:29], v[38:39], v[42:43] op_sel:[1,1] op_sel_hi:[1,0] neg_lo:[0,1]
    v_pk_fma_f32 v[30:31], v[38:39], v[42:43], v[28:29] op_sel:[0,0,0] op_sel_hi:[0,1,1]
    v_cvt_pk_bf16_f32 v115, v68, v70
    v_cvt_pk_bf16_f32 v131, v69, v71
    v_pk_mul_f32 v[26:27], v[62:63], v[40:41] op_sel:[1,1] op_sel_hi:[1,0] neg_lo:[0,1]
    v_pk_fma_f32 v[72:73], v[62:63], v[40:41], v[26:27] op_sel:[0,0,0] op_sel_hi:[0,1,1]
    v_pk_mul_f32 v[28:29], v[30:31], v[42:43] op_sel:[1,1] op_sel_hi:[1,0] neg_lo:[0,1]
    v_pk_fma_f32 v[38:39], v[30:31], v[42:43], v[28:29] op_sel:[0,0,0] op_sel_hi:[0,1,1]
    v_cvt_pk_bf16_f32 v117, v62, v72
    v_cvt_pk_bf16_f32 v133, v63, v73
    v_cvt_pk_bf16_f32 v150, v30, v38
    v_cvt_pk_bf16_f32 v166, v31, v39
    v_pk_mul_f32 v[26:27], v[72:73], v[40:41] op_sel:[1,1] op_sel_hi:[1,0] neg_lo:[0,1]
    v_pk_fma_f32 v[74:75], v[72:73], v[40:41], v[26:27] op_sel:[0,0,0] op_sel_hi:[0,1,1]
    v_pk_mul_f32 v[28:29], v[38:39], v[42:43] op_sel:[1,1] op_sel_hi:[1,0] neg_lo:[0,1]
    v_pk_fma_f32 v[30:31], v[38:39], v[42:43], v[28:29] op_sel:[0,0,0] op_sel_hi:[0,1,1]
    v_pk_mul_f32 v[26:27], v[74:75], v[40:41] op_sel:[1,1] op_sel_hi:[1,0] neg_lo:[0,1]
    v_pk_fma_f32 v[76:77], v[74:75], v[40:41], v[26:27] op_sel:[0,0,0] op_sel_hi:[0,1,1]
    v_pk_mul_f32 v[28:29], v[30:31], v[42:43] op_sel:[1,1] op_sel_hi:[1,0] neg_lo:[0,1]
    v_pk_fma_f32 v[38:39], v[30:31], v[42:43], v[28:29] op_sel:[0,0,0] op_sel_hi:[0,1,1]
    v_cvt_pk_bf16_f32 v120, v74, v76
    v_cvt_pk_bf16_f32 v136, v75, v77
    v_cvt_pk_bf16_f32 v151, v30, v38
    v_cvt_pk_bf16_f32 v167, v31, v39
    v_pk_mul_f32 v[26:27], v[76:77], v[40:41] op_sel:[1,1] op_sel_hi:[1,0] neg_lo:[0,1]
    v_pk_fma_f32 v[78:79], v[76:77], v[40:41], v[26:27] op_sel:[0,0,0] op_sel_hi:[0,1,1]
    v_pk_mul_f32 v[28:29], v[38:39], v[42:43] op_sel:[1,1] op_sel_hi:[1,0] neg_lo:[0,1]
    v_pk_fma_f32 v[30:31], v[38:39], v[42:43], v[28:29] op_sel:[0,0,0] op_sel_hi:[0,1,1]
    v_cvt_pk_bf16_f32 v121, v78, v78
    v_cvt_pk_bf16_f32 v137, v79, v79
    s_waitcnt vmcnt(0)
    s_nop 0
    v_perm_b32 v176, v16, v12, s50
    ds_write_b32 v4, v176 offset:0
    v_perm_b32 v177, v16, v12, s51
    ds_write_b32 v4, v177 offset:128
    v_perm_b32 v178, v17, v13, s50
    ds_write_b32 v4, v178 offset:256
    v_perm_b32 v179, v17, v13, s51
    ds_write_b32 v4, v179 offset:384
    v_perm_b32 v180, v18, v14, s50
    ds_write_b32 v4, v180 offset:512
    v_perm_b32 v181, v18, v14, s51
    ds_write_b32 v4, v181 offset:640
    v_perm_b32 v182, v19, v15, s50
    ds_write_b32 v4, v182 offset:768
    v_perm_b32 v183, v19, v15, s51
    ds_write_b32 v4, v183 offset:896
    s_waitcnt lgkmcnt(0)
    s_barrier
    ds_read_b128 v[12:15], v5 offset:0
    ds_read_b128 v[16:19], v6 offset:0
    s_waitcnt lgkmcnt(1)
    global_store_dwordx4 v200, v[12:15], s[34:35] sc1
    s_waitcnt lgkmcnt(0)
    global_store_dwordx4 v201, v[16:19], s[34:35] sc1
    s_setprio 0
    s_nop 0
    v_pk_mul_f32 v[26:27], v[74:75], v[44:45] op_sel:[1,1] op_sel_hi:[1,0] neg_lo:[0,1]
    v_pk_fma_f32 v[80:81], v[74:75], v[44:45], v[26:27] op_sel:[0,0,0] op_sel_hi:[0,1,1]
    v_pk_mul_f32 v[28:29], v[30:31], v[42:43] op_sel:[1,1] op_sel_hi:[1,0] neg_lo:[0,1]
    v_pk_fma_f32 v[38:39], v[30:31], v[42:43], v[28:29] op_sel:[0,0,0] op_sel_hi:[0,1,1]
    v_cvt_pk_bf16_f32 v152, v30, v38
    v_cvt_pk_bf16_f32 v168, v31, v39
    v_pk_mul_f32 v[26:27], v[78:79], v[44:45] op_sel:[1,1] op_sel_hi:[1,0] neg_lo:[0,1]
    v_pk_fma_f32 v[82:83], v[78:79], v[44:45], v[26:27] op_sel:[0,0,0] op_sel_hi:[0,1,1]
    v_pk_mul_f32 v[28:29], v[38:39], v[42:43] op_sel:[1,1] op_sel_hi:[1,0] neg_lo:[0,1]
    v_pk_fma_f32 v[30:31], v[38:39], v[42:43], v[28:29] op_sel:[0,0,0] op_sel_hi:[0,1,1]
    v_cvt_pk_bf16_f32 v118, v80, v82
    v_cvt_pk_bf16_f32 v134, v81, v83
    v_pk_mul_f32 v[26:27], v[64:65], v[44:45] op_sel:[1,1] op_sel_hi:[1,0] neg_lo:[0,1]
    v_pk_fma_f32 v[84:85], v[64:65], v[44:45], v[26:27] op_sel:[0,0,0] op_sel_hi:[0,1,1]
    v_pk_mul_f32 v[28:29], v[30:31], v[42:43] op_sel:[1,1] op_sel_hi:[1,0] neg_lo:[0,1]
    v_pk_fma_f32 v[38:39], v[30:31], v[42:43], v[28:29] op_sel:[0,0,0] op_sel_hi:[0,1,1]
    v_cvt_pk_bf16_f32 v153, v30, v38
    v_cvt_pk_bf16_f32 v169, v31, v39
    v_pk_mul_f32 v[26:27], v[68:69], v[44:45] op_sel:[1,1] op_sel_hi:[1,0] neg_lo:[0,1]
    v_pk_fma_f32 v[86:87], v[68:69], v[44:45], v[26:27] op_sel:[0,0,0] op_sel_hi:[0,1,1]
    v_pk_mul_f32 v[28:29], v[38:39], v[42:43] op_sel:[1,1] op_sel_hi:[1,0] neg_lo:[0,1]
    v_pk_fma_f32 v[30:31], v[38:39], v[42:43], v[28:29] op_sel:[0,0,0] op_sel_hi:[0,1,1]
    v_cvt_pk_bf16_f32 v119, v84, v86
    v_cvt_pk_bf16_f32 v135, v85, v87
    v_pk_mul_f32 v[26:27], v[80:81], v[44:45] op_sel:[1,1] op_sel_hi:[1,0] neg_lo:[0,1]
    v_pk_fma_f32 v[88:89], v[80:81], v[44:45], v[26:27] op_sel:[0,0,0] op_sel_hi:[0,1,1]
    v_pk_mul_f32 v[28:29], v[30:31], v[42:43] op_sel:[1,1] op_sel_hi:[1,0] neg_lo:[0,1]
    v_pk_fma_f32 v[38:39], v[30:31], v[42:43], v[28:29] op_sel:[0,0,0] op_sel_hi:[0,1,1]
    v_cvt_pk_bf16_f32 v154, v30, v38
    v_cvt_pk_bf16_f32 v170, v31, v39
    v_pk_mul_f32 v[26:27], v[84:85], v[44:45] op_sel:[1,1] op_sel_hi:[1,0] neg_lo:[0,1]
    v_pk_fma_f32 v[90:91], v[84:85], v[44:45], v[26:27] op_sel:[0,0,0] op_sel_hi:[0,1,1]
    v_pk_mul_f32 v[28:29], v[38:39], v[42:43] op_sel:[1,1] op_sel_hi:[1,0] neg_lo:[0,1]
    v_pk_fma_f32 v[30:31], v[38:39], v[42:43], v[28:29] op_sel:[0,0,0] op_sel_hi:[0,1,1]
    v_cvt_pk_bf16_f32 v122, v88, v90
    v_cvt_pk_bf16_f32 v138, v89, v91
    v_pk_mul_f32 v[26:27], v[86:87], v[44:45] op_sel:[1,1] op_sel_hi:[1,0] neg_lo:[0,1]
    v_pk_fma_f32 v[92:93], v[86:87], v[44:45], v[26:27] op_sel:[0,0,0] op_sel_hi:[0,1,1]
    v_pk_mul_f32 v[28:29], v[30:31], v[42:43] op_sel:[1,1] op_sel_hi:[1,0] neg_lo:[0,1]
    v_pk_fma_f32 v[38:39], v[30:31], v[42:43], v[28:29] op_sel:[0,0,0] op_sel_hi:[0,1,1]
    v_cvt_pk_bf16_f32 v155, v30, v38
    v_cvt_pk_bf16_f32 v171, v31, v39
    v_pk_mul_f32 v[26:27], v[88:89], v[44:45] op_sel:[1,1] op_sel_hi:[1,0] neg_lo:[0,1]
    v_pk_fma_f32 v[94:95], v[88:89], v[44:45], v[26:27] op_sel:[0,0,0] op_sel_hi:[0,1,1]
    v_pk_mul_f32 v[28:29], v[38:39], v[42:43] op_sel:[1,1] op_sel_hi:[1,0] neg_lo:[0,1]
    v_pk_fma_f32 v[30:31], v[38:39], v[42:43], v[28:29] op_sel:[0,0,0] op_sel_hi:[0,1,1]
    v_cvt_pk_bf16_f32 v123, v92, v94
    v_cvt_pk_bf16_f32 v139, v93, v95
    v_pk_mul_f32 v[26:27], v[90:91], v[44:45] op_sel:[1,1] op_sel_hi:[1,0] neg_lo:[0,1]
    v_pk_fma_f32 v[96:97], v[90:91], v[44:45], v[26:27] op_sel:[0,0,0] op_sel_hi:[0,1,1]
    v_pk_mul_f32 v[28:29], v[30:31], v[42:43] op_sel:[1,1] op_sel_hi:[1,0] neg_lo:[0,1]
    v_pk_fma_f32 v[38:39], v[30:31], v[42:43], v[28:29] op_sel:[0,0,0] op_sel_hi:[0,1,1]
    v_cvt_pk_bf16_f32 v156, v30, v38
    v_cvt_pk_bf16_f32 v172, v31, v39
    v_pk_mul_f32 v[26:27], v[94:95], v[44:45] op_sel:[1,1] op_sel_hi:[1,0] neg_lo:[0,1]
    v_pk_fma_f32 v[98:99], v[94:95], v[44:45], v[26:27] op_sel:[0,0,0] op_sel_hi:[0,1,1]
    v_pk_mul_f32 v[28:29], v[38:39], v[42:43] op_sel:[1,1] op_sel_hi:[1,0] neg_lo:[0,1]
    v_pk_fma_f32 v[30:31], v[38:39], v[42:43], v[28:29] op_sel:[0,0,0] op_sel_hi:[0,1,1]
    v_cvt_pk_bf16_f32 v124, v96, v98
    v_cvt_pk_bf16_f32 v140, v97, v99
    v_pk_mul_f32 v[26:27], v[96:97], v[44:45] op_sel:[1,1] op_sel_hi:[1,0] neg_lo:[0,1]
    v_pk_fma_f32 v[100:101], v[96:97], v[44:45], v[26:27] op_sel:[0,0,0] op_sel_hi:[0,1,1]
    v_pk_mul_f32 v[28:29], v[30:31], v[42:43] op_sel:[1,1] op_sel_hi:[1,0] neg_lo:[0,1]
    v_pk_fma_f32 v[38:39], v[30:31], v[42:43], v[28:29] op_sel:[0,0,0] op_sel_hi:[0,1,1]
    v_cvt_pk_bf16_f32 v157, v30, v38
    v_cvt_pk_bf16_f32 v173, v31, v39
    v_pk_mul_f32 v[26:27], v[98:99], v[44:45] op_sel:[1,1] op_sel_hi:[1,0] neg_lo:[0,1]
    v_pk_fma_f32 v[102:103], v[98:99], v[44:45], v[26:27] op_sel:[0,0,0] op_sel_hi:[0,1,1]
    v_pk_mul_f32 v[28:29], v[38:39], v[42:43] op_sel:[1,1] op_sel_hi:[1,0] neg_lo:[0,1]
    v_pk_fma_f32 v[30:31], v[38:39], v[42:43], v[28:29] op_sel:[0,0,0] op_sel_hi:[0,1,1]
    v_cvt_pk_bf16_f32 v125, v100, v102
    v_cvt_pk_bf16_f32 v141, v101, v103
    v_pk_mul_f32 v[26:27], v[100:101], v[44:45] op_sel:[1,1] op_sel_hi:[1,0] neg_lo:[0,1]
    v_pk_fma_f32 v[104:105], v[100:101], v[44:45], v[26:27] op_sel:[0,0,0] op_sel_hi:[0,1,1]
    v_pk_mul_f32 v[28:29], v[30:31], v[42:43] op_sel:[1,1] op_sel_hi:[1,0] neg_lo:[0,1]
    v_pk_fma_f32 v[38:39], v[30:31], v[42:43], v[28:29] op_sel:[0,0,0] op_sel_hi:[0,1,1]
    v_cvt_pk_bf16_f32 v158, v30, v38
    v_cvt_pk_bf16_f32 v174, v31, v39
    v_pk_mul_f32 v[26:27], v[102:103], v[44:45] op_sel:[1,1] op_sel_hi:[1,0] neg_lo:[0,1]
    v_pk_fma_f32 v[106:107], v[102:103], v[44:45], v[26:27] op_sel:[0,0,0] op_sel_hi:[0,1,1]
    v_pk_mul_f32 v[28:29], v[38:39], v[42:43] op_sel:[1,1] op_sel_hi:[1,0] neg_lo:[0,1]
    v_pk_fma_f32 v[30:31], v[38:39], v[42:43], v[28:29] op_sel:[0,0,0] op_sel_hi:[0,1,1]
    v_cvt_pk_bf16_f32 v126, v104, v106
    v_cvt_pk_bf16_f32 v142, v105, v107
    v_pk_mul_f32 v[26:27], v[104:105], v[44:45] op_sel:[1,1] op_sel_hi:[1,0] neg_lo:[0,1]
    v_pk_fma_f32 v[108:109], v[104:105], v[44:45], v[26:27] op_sel:[0,0,0] op_sel_hi:[0,1,1]
    v_pk_mul_f32 v[28:29], v[30:31], v[42:43] op_sel:[1,1] op_sel_hi:[1,0] neg_lo:[0,1]
    v_pk_fma_f32 v[38:39], v[30:31], v[42:43], v[28:29] op_sel:[0,0,0] op_sel_hi:[0,1,1]
    v_cvt_pk_bf16_f32 v159, v30, v38
    v_cvt_pk_bf16_f32 v175, v31, v39
    v_pk_mul_f32 v[26:27], v[106:107], v[44:45] op_sel:[1,1] op_sel_hi:[1,0] neg_lo:[0,1]
    v_pk_fma_f32 v[110:111], v[106:107], v[44:45], v[26:27] op_sel:[0,0,0] op_sel_hi:[0,1,1]
    v_cvt_pk_bf16_f32 v127, v108, v110
    v_cvt_pk_bf16_f32 v143, v109, v111
    s_waitcnt vmcnt(0)
    s_mov_b64 exec, 1
    global_store_dword v202, v234, s[34:35] sc1
    s_mov_b64 exec, -1
    s_nop 0
    ds_write_b128 v226, v[144:147] offset:16384
    ds_write_b128 v230, v[160:163] offset:16384
    ds_write_b128 v226, v[112:115]
    ds_write_b128 v230, v[128:131]
    ds_write_b128 v227, v[148:151] offset:16384
    ds_write_b128 v231, v[164:167] offset:16384
    ds_write_b128 v227, v[116:119]
    ds_write_b128 v231, v[132:135]
    ds_write_b128 v228, v[152:155] offset:16384
    ds_write_b128 v232, v[168:171] offset:16384
    ds_write_b128 v228, v[120:123]
    ds_write_b128 v232, v[136:139]
    ds_write_b128 v229, v[156:159] offset:16384
    ds_write_b128 v233, v[172:175] offset:16384
    ds_write_b128 v229, v[124:127]
    ds_write_b128 v233, v[140:143]
    v_and_b32 v7, 31, v1
    v_lshrrev_b32 v8, 5, v1
    v_lshlrev_b32_e64 v206, 4, v7
    s_add_u32 s42, s55, 528
    v_sub_u32 v206, s42, v206
    v_lshlrev_b32 v7, 10, v8
    v_sub_u32 v207, v206, v7
    v_mov_b32 v208, s55
    v_bfe_u32 v7, v1, 3, 1
    v_lshl_add_u32 v7, v8, 2, v7
    v_bfe_u32 v9, v1, 2, 1
    v_bfe_u32 v20, v1, 4, 1
    v_lshl_add_u32 v9, v9, 1, v20
    v_bfe_u32 v20, v1, 1, 1
    v_lshl_add_u32 v9, v9, 1, v20
    v_xor_b32 v9, v9, v7
    v_lshlrev_b32 v9, 4, v9
    v_lshl_add_u32 v9, v7, 7, v9
    v_and_b32_e64 v20, 1, v1
    v_lshl_add_u32 v9, v20, 3, v9
    s_lshl_b32 s42, s41, 13
    s_add_u32 s42, s42, s55
    v_add_u32 v222, s42, v9
    v_xor_b32 v223, 32, v222
    v_add_u32 v223, 256, v223
    s_add_u32 s43, s42, 17408
    v_lshl_add_u32 v250, v1, 4, s43
    s_lshl_b32 s42, s41, 14
    s_sub_u32 s43, s43, s42
    s_add_u32 s43, s43, 8192
    v_lshl_add_u32 v251, v1, 4, s43
    global_load_dword v224, v203, s[34:35] sc1
    s_waitcnt lgkmcnt(0)
    s_nop 0
    ds_read_b64_tr_b16 v[48:49], v222 offset:0
    ds_read_b64_tr_b16 v[50:51], v223 offset:0
    ds_read_b64_tr_b16 v[80:81], v222 offset:16384
    ds_read_b64_tr_b16 v[82:83], v223 offset:16384
    ds_read_b64_tr_b16 v[52:53], v222 offset:1024
    ds_read_b64_tr_b16 v[54:55], v223 offset:1024
    ds_read_b64_tr_b16 v[84:85], v222 offset:17408
    ds_read_b64_tr_b16 v[86:87], v223 offset:17408
    ds_read_b64_tr_b16 v[56:57], v222 offset:2048
    ds_read_b64_tr_b16 v[58:59], v223 offset:2048
    ds_read_b64_tr_b16 v[88:89], v222 offset:18432
    ds_read_b64_tr_b16 v[90:91], v223 offset:18432
    ds_read_b64_tr_b16 v[60:61], v222 offset:3072
    ds_read_b64_tr_b16 v[62:63], v223 offset:3072
    ds_read_b64_tr_b16 v[92:93], v222 offset:19456
    ds_read_b64_tr_b16 v[94:95], v223 offset:19456
    ds_read_b64_tr_b16 v[64:65], v222 offset:4096
    ds_read_b64_tr_b16 v[66:67], v223 offset:4096
    ds_read_b64_tr_b16 v[96:97], v222 offset:20480
    ds_read_b64_tr_b16 v[98:99], v223 offset:20480
    s_waitcnt lgkmcnt(15)
    v_mfma_f32_32x32x16_bf16 v[32:47], v[48:51], v[80:83], 0
    v_and_b32 v20, 15, v1
    v_lshrrev_b32 v21, 4, v1
    v_sub_u32 v7, 2, v20
    ds_read_b64_tr_b16 v[68:69], v222 offset:5120
    ds_read_b64_tr_b16 v[70:71], v223 offset:5120
    ds_read_b64_tr_b16 v[100:101], v222 offset:21504
    ds_read_b64_tr_b16 v[102:103], v223 offset:21504
    s_waitcnt lgkmcnt(15)
    v_mfma_f32_32x32x16_bf16 v[32:47], v[52:55], v[84:87], v[32:47]
    v_and_b32 v7, 3, v7
    v_lshlrev_b32 v8, 3, v21
    v_sub_u32 v8, v8, v20
    ds_read_b64_tr_b16 v[72:73], v222 offset:6144
    ds_read_b64_tr_b16 v[74:75], v223 offset:6144
    ds_read_b64_tr_b16 v[104:105], v222 offset:22528
    ds_read_b64_tr_b16 v[106:107], v223 offset:22528
    s_waitcnt lgkmcnt(15)
    v_mfma_f32_32x32x16_bf16 v[32:47], v[56:59], v[88:91], v[32:47]
    v_sub_u32 v8, v8, v7
    v_mul_u32_u24 v7, 4160, v7
    s_lshl_b32 s42, s41, 8
    ds_read_b64_tr_b16 v[76:77], v222 offset:7168
    ds_read_b64_tr_b16 v[78:79], v223 offset:7168
    ds_read_b64_tr_b16 v[108:109], v222 offset:23552
    ds_read_b64_tr_b16 v[110:111], v223 offset:23552
    s_waitcnt lgkmcnt(15)
    v_mfma_f32_32x32x16_bf16 v[32:47], v[60:63], v[92:95], v[32:47]
    s_sub_u32 s43, s55, s42
    s_add_u32 s43, s43, 324
    v_lshl_add_u32 v211, v8, 1, v7
    s_waitcnt lgkmcnt(12)
    v_mfma_f32_32x32x16_bf16 v[32:47], v[64:67], v[96:99], v[32:47]
    v_add_u32 v211, s43, v211
    s_sub_u32 s43, s54, s42
    s_add_u32 s43, s43, 288
    v_lshlrev_b32_e64 v7, 5, v20
    v_lshl_add_u32 v212, v21, 4, v7
    v_add_u32 v212, s43, v212
    s_waitcnt lgkmcnt(8)
    v_mfma_f32_32x32x16_bf16 v[32:47], v[68:71], v[100:103], v[32:47]
    s_add_u32 s43, s54, s42
    v_lshl_add_u32 v210, v1, 2, s43
    s_lshl_b32 s42, s41, 11
    s_add_u32 s43, s54, s42
    v_lshl_add_u32 v209, v1, 4, s43
    v_lshl_add_u32 v7, v21, 3, v7
    s_waitcnt lgkmcnt(4)
    v_mfma_f32_32x32x16_bf16 v[32:47], v[72:75], v[104:107], v[32:47]
    s_add_u32 s43, s55, s42
    s_add_u32 s43, s43, 24832
    v_add_u32 v216, s43, v7
    v_lshl_add_u32 v217, v1, 4, s43
    s_lshl_b32 s42, s41, 12
    s_add_u32 s43, s55, 16640
    s_waitcnt lgkmcnt(0)
    v_mfma_f32_32x32x16_bf16 v[32:47], v[76:79], v[108:111], v[32:47]
    s_add_u32 s44, s43, s42
    v_lshl_add_u32 v213, v1, 4, s44
    s_xor_b32 s42, s42, 4096
    s_add_u32 s44, s43, s42
    v_lshl_add_u32 v214, v1, 4, s44
    s_mov_b32 s56, 0x80000000
    s_mov_b32 s57, 0
    s_mov_b32 s58, 0
    s_mov_b32 s59, 0x80000000
    s_mov_b32 s60, 0xaaaaaaaa
    s_mov_b32 s61, 0xaaaaaaaa
    s_nop 0
    ds_write_b128 v250, v[32:35] offset:0
    ds_write_b128 v250, v[36:39] offset:1024
    ds_write_b128 v250, v[40:43] offset:2048
    ds_write_b128 v250, v[44:47] offset:3072
    s_waitcnt vmcnt(0)
    v_xor_b32 v9, v234, v224
    v_cmp_lt_u32 vcc, 15, v9
    s_nop 0
    s_cbranch_vccnz A_fu_r
A_fu_k:
    v_cmp_ne_u32 vcc, 0, v9
    s_nop 1
    v_mov_b32_e64 v9, vcc_lo
    ds_write_b32 v235, v9
    v_and_b32_e64 v235, -16, v235
    s_waitcnt lgkmcnt(0)
    s_barrier
    ds_read_b128 v[184:187], v235
    ds_read_b128 v[112:115], v251 offset:0
    ds_read_b128 v[116:119], v251 offset:1024
    ds_read_b128 v[120:123], v251 offset:2048
    ds_read_b128 v[124:127], v251 offset:3072
    s_waitcnt lgkmcnt(4)
    v_or3_b32 v184, v184, v185, v186
    v_or_b32 v184, v184, v187
    s_nop 0
    v_readfirstlane_b32 s63, v184
    global_load_dwordx4 v[12:15], v204, s[34:35] sc1
    global_load_dwordx4 v[16:19], v204, s[34:35] offset:1024 sc1
A_uback:
    s_waitcnt lgkmcnt(3)
    v_add_f32 v32, v32, v112
    v_add_f32 v33, v33, v113
    v_add_f32 v34, v34, v114
    v_add_f32 v35, v35, v115
    s_waitcnt lgkmcnt(2)
    v_add_f32 v36, v36, v116
    v_add_f32 v37, v37, v117
    v_add_f32 v38, v38, v118
    v_add_f32 v39, v39, v119
    s_waitcnt lgkmcnt(1)
    v_add_f32 v40, v40, v120
    v_add_f32 v41, v41, v121
    v_add_f32 v42, v42, v122
    v_add_f32 v43, v43, v123
    s_waitcnt lgkmcnt(0)
    v_add_f32 v44, v44, v124
    v_add_f32 v45, v45, v125
    v_add_f32 v46, v46, v126
    v_add_f32 v47, v47, v127
    s_mov_b64 exec, 1
    v_add_f32_e64 v32, s48, v32
    s_mov_b64 exec, -1
    v_cndmask_b32 v41, v41, v40, s[56:57]
    v_cndmask_b32 v37, v37, v36, s[58:59]
    v_cndmask_b32 v48, v44, v45, s[60:61]
    v_cndmask_b32 v49, v46, v47, s[60:61]
    ds_write_b32 v210, v240
    s_cmp_eq_u32 s41, 1
    s_cbranch_scc1 A_exp1
    v_cvt_pk_bf16_f32 v52, v45, v45
    v_cvt_pk_bf16_f32 v53, v45, v45
    v_cvt_pk_bf16_f32 v54, v45, v45
    v_cvt_pk_bf16_f32 v55, v48, v44
    ds_write_b128 v207, v[52:55] offset:1536
    v_cvt_pk_bf16_f32 v56, v45, v45
    v_cvt_pk_bf16_f32 v57, v45, v45
    v_cvt_pk_bf16_f32 v58, v45, v48
    v_cvt_pk_bf16_f32 v59, v44, v44
    ds_write_b128 v207, v[56:59] offset:5696
    v_cvt_pk_bf16_f32 v60, v47, v47
    v_cvt_pk_bf16_f32 v61, v47, v47
    v_cvt_pk_bf16_f32 v62, v47, v47
    v_cvt_pk_bf16_f32 v63, v49, v46
    ds_write_b128 v207, v[60:63] offset:1024
    v_cvt_pk_bf16_f32 v64, v47, v47
    v_cvt_pk_bf16_f32 v65, v47, v47
    v_cvt_pk_bf16_f32 v66, v47, v49
    v_cvt_pk_bf16_f32 v67, v46, v46
    ds_write_b128 v207, v[64:67] offset:5184
    s_mov_b32 exec_lo, 0
    s_mov_b32 exec_hi, -1
    v_cvt_pk_bf16_f32 v68, v37, v36
    v_cvt_pk_bf16_f32 v69, v36, v36
    v_cvt_pk_bf16_f32 v70, v35, v34
    v_cvt_pk_bf16_f32 v71, v34, v34
    ds_write_b128 v206, v[68:71] offset:3072
    v_cvt_pk_bf16_f32 v72, v36, v36
    v_cvt_pk_bf16_f32 v73, v36, v35
    v_cvt_pk_bf16_f32 v74, v34, v34
    v_cvt_pk_bf16_f32 v75, v34, v33
    ds_write_b128 v206, v[72:75] offset:7232
    v_cvt_pk_bf16_f32 v76, v40, v40
    v_cvt_pk_bf16_f32 v77, v40, v40
    v_cvt_pk_bf16_f32 v78, v40, v39
    v_cvt_pk_bf16_f32 v79, v39, v39
    ds_write_b128 v206, v[76:79] offset:2560
    v_cvt_pk_bf16_f32 v80, v40, v40
    v_cvt_pk_bf16_f32 v81, v40, v40
    v_cvt_pk_bf16_f32 v82, v39, v39
    v_cvt_pk_bf16_f32 v83, v39, v38
    ds_write_b128 v206, v[80:83] offset:6720
    v_cvt_pk_bf16_f32 v84, v43, v43
    v_cvt_pk_bf16_f32 v85, v43, v43
    v_cvt_pk_bf16_f32 v86, v43, v42
    v_cvt_pk_bf16_f32 v87, v42, v42
    ds_write_b128 v206, v[84:87] offset:2048
    v_cvt_pk_bf16_f32 v88, v43, v43
    v_cvt_pk_bf16_f32 v89, v43, v43
    v_cvt_pk_bf16_f32 v90, v42, v42
    v_cvt_pk_bf16_f32 v91, v42, v41
    ds_write_b128 v206, v[88:91] offset:6208
    s_mov_b32 exec_lo, -1
    s_mov_b32 exec_hi, 0
    v_cvt_pk_bf16_f32 v92, v42, v41
    v_cvt_pk_bf16_f32 v93, v40, v39
    v_cvt_pk_bf16_f32 v94, v38, v37
    v_cvt_pk_bf16_f32 v95, v36, v35
    ds_write_b128 v206, v[92:95] offset:3584
    v_cvt_pk_bf16_f32 v96, v41, v40
    v_cvt_pk_bf16_f32 v97, v39, v38
    v_cvt_pk_bf16_f32 v98, v37, v36
    v_cvt_pk_bf16_f32 v99, v35, v34
    ds_write_b128 v206, v[96:99] offset:7744
    s_mov_b64 exec, 1
    ds_write_b128 v208, v[240:243] offset:4144
    v_cvt_pk_bf16_f32 v100, v34, v33
    v_cvt_pk_bf16_f32 v101, v32, 0
    v_mov_b32 v102, 0
    v_mov_b32_e64 v103, 0
    ds_write_b128 v208, v[100:103] offset:4128
    ds_write_b128 v208, v[240:243] offset:8304
    v_cvt_pk_bf16_f32 v104, v33, v32
    v_mov_b32 v105, 0
    v_mov_b32 v106, 0
    v_mov_b32_e64 v107, 0
    ds_write_b128 v208, v[104:107] offset:8288
    s_mov_b64 exec, -1
    s_branch A_exp_done
A_exp1:
    v_cvt_pk_bf16_f32 v52, v45, v45
    v_cvt_pk_bf16_f32 v53, v45, v45
    v_cvt_pk_bf16_f32 v54, v48, v44
    v_cvt_pk_bf16_f32 v55, v44, v44
    ds_write_b128 v207, v[52:55] offset:9856
    v_cvt_pk_bf16_f32 v56, v45, v45
    v_cvt_pk_bf16_f32 v57, v45, v48
    v_cvt_pk_bf16_f32 v58, v44, v44
    v_cvt_pk_bf16_f32 v59, v44, v44
    ds_write_b128 v207, v[56:59] offset:14016
    v_cvt_pk_bf16_f32 v60, v47, v47
    v_cvt_pk_bf16_f32 v61, v47, v47
    v_cvt_pk_bf16_f32 v62, v49, v46
    v_cvt_pk_bf16_f32 v63, v46, v46
    ds_write_b128 v207, v[60:63] offset:9344
    v_cvt_pk_bf16_f32 v64, v47, v47
    v_cvt_pk_bf16_f32 v65, v47, v49
    v_cvt_pk_bf16_f32 v66, v46, v46
    v_cvt_pk_bf16_f32 v67, v46, v46
    ds_write_b128 v207, v[64:67] offset:13504
    s_mov_b32 exec_lo, 0
    s_mov_b32 exec_hi, -1
    v_cvt_pk_bf16_f32 v68, v36, v36
    v_cvt_pk_bf16_f32 v69, v35, v34
    v_cvt_pk_bf16_f32 v70, v34, v34
    v_cvt_pk_bf16_f32 v71, v33, v32
    ds_write_b128 v206, v[68:71] offset:11392
    v_cvt_pk_bf16_f32 v72, v36, v35
    v_cvt_pk_bf16_f32 v73, v34, v34
    v_cvt_pk_bf16_f32 v74, v34, v33
    v_cvt_pk_bf16_f32 v75, v32, v32
    ds_write_b128 v206, v[72:75] offset:15552
    v_cvt_pk_bf16_f32 v76, v40, v40
    v_cvt_pk_bf16_f32 v77, v40, v39
    v_cvt_pk_bf16_f32 v78, v39, v39
    v_cvt_pk_bf16_f32 v79, v38, v38
    ds_write_b128 v206, v[76:79] offset:10880
    v_cvt_pk_bf16_f32 v80, v40, v40
    v_cvt_pk_bf16_f32 v81, v39, v39
    v_cvt_pk_bf16_f32 v82, v39, v38
    v_cvt_pk_bf16_f32 v83, v38, v38
    ds_write_b128 v206, v[80:83] offset:15040
    v_cvt_pk_bf16_f32 v84, v43, v43
    v_cvt_pk_bf16_f32 v85, v43, v42
    v_cvt_pk_bf16_f32 v86, v42, v42
    v_cvt_pk_bf16_f32 v87, v41, v41
    ds_write_b128 v206, v[84:87] offset:10368
    v_cvt_pk_bf16_f32 v88, v43, v43
    v_cvt_pk_bf16_f32 v89, v42, v42
    v_cvt_pk_bf16_f32 v90, v42, v41
    v_cvt_pk_bf16_f32 v91, v41, v41
    ds_write_b128 v206, v[88:91] offset:14528
    s_mov_b32 exec_lo, -1
    s_mov_b32 exec_hi, 0
    v_cvt_pk_bf16_f32 v92, v40, v39
    v_cvt_pk_bf16_f32 v93, v38, v37
    v_cvt_pk_bf16_f32 v94, v36, v35
    v_cvt_pk_bf16_f32 v95, v34, v33
    ds_write_b128 v206, v[92:95] offset:11904
    v_cvt_pk_bf16_f32 v96, v39, v38
    v_cvt_pk_bf16_f32 v97, v37, v36
    v_cvt_pk_bf16_f32 v98, v35, v34
    v_cvt_pk_bf16_f32 v99, v33, v32
    ds_write_b128 v206, v[96:99] offset:16064
    s_mov_b64 exec, 1
    ds_write_b128 v208, v[240:243] offset:12464
    v_cvt_pk_bf16_f32 v100, v32, 0
    v_mov_b32 v101, 0
    v_mov_b32 v102, 0
    v_mov_b32 v103, 0
    ds_write_b128 v208, v[100:103] offset:12448
    ds_write_b128 v208, v[240:243] offset:16624
    ds_write_b128 v208, v[240:243] offset:16608
    s_mov_b64 exec, -1
A_exp_done:
    s_waitcnt vmcnt(1)
    ds_write_b128 v209, v[12:15] offset:512
    s_waitcnt vmcnt(0)
    ds_write_b128 v209, v[16:19] offset:1536
    s_cmp_eq_u32 s63, 0
    s_cbranch_scc1 A_yc_loc
    global_store_dwordx4 v204, v[236:239], s[34:35] sc1
    global_store_dwordx4 v204, v[236:239], s[34:35] offset:1024 sc1
    s_branch A_yc_done
A_yc_loc:
    global_store_dwordx4 v204, v[236:239], s[34:35]
    global_store_dwordx4 v204, v[236:239], s[34:35] offset:1024
A_yc_done:
    s_mov_b32 exec_lo, 0x11111111
    s_mov_b32 exec_hi, 0x11111111
    global_load_dword v246, v204, s[34:35] sc1
    global_load_dword v247, v204, s[34:35] offset:1024 sc1
    s_mov_b64 exec, -1
    s_lshl_b32 s43, s37, 7
    s_add_u32 s43, s43, 7356544
    v_mov_b32_e64 v9, s43
    s_or_b32 s42, s38, s39
    s_cmp_lg_u32 s42, 0
    s_cbranch_scc1 A_noep
    s_mov_b64 exec, 1
    global_store_dword v9, v10, s[34:35] sc1
    s_mov_b64 exec, -1
A_noep:
    s_waitcnt lgkmcnt(0)
    s_barrier
    s_setprio 0
    ds_read_b128 v[96:99], v212 offset:192
    ds_read_b64 v[64:65], v211 offset:3776
    ds_read_b64 v[66:67], v211 offset:3784
    ds_read_b128 v[100:103], v212 offset:704
    ds_read_b64 v[68:69], v211 offset:3264
    ds_read_b64 v[70:71], v211 offset:3272
    ds_read_b128 v[104:107], v212 offset:1216
    ds_read_b64 v[72:73], v211 offset:2752
    ds_read_b64 v[74:75], v211 offset:2760
    ds_read_b128 v[108:111], v212 offset:1728
    ds_read_b64 v[76:77], v211 offset:2240
    ds_read_b64 v[78:79], v211 offset:2248
    s_waitcnt lgkmcnt(9)
    v_mfma_f32_16x16x32_bf16 v[32:35], v[64:67], v[96:99], 0
    ds_read_b128 v[112:115], v212 offset:2240
    s_waitcnt lgkmcnt(9)
    v_mfma_f32_16x16x32_bf16 v[36:39], v[64:67], v[100:103], 0
    ds_read_b64 v[80:81], v211 offset:1728
    s_waitcnt lgkmcnt(8)
    v_mfma_f32_16x16x32_bf16 v[36:39], v[68:71], v[96:99], v[36:39]
    ds_read_b64 v[82:83], v211 offset:1736
    v_mfma_f32_16x16x32_bf16 v[40:43], v[68:71], v[100:103], 0
    ds_read_b128 v[116:119], v212 offset:2752
    s_waitcnt lgkmcnt(9)
    v_mfma_f32_16x16x32_bf16 v[40:43], v[64:67], v[104:107], v[40:43]
    ds_read_b64 v[84:85], v211 offset:1216
    s_waitcnt lgkmcnt(8)
    s_nop 0
    v_mfma_f32_16x16x32_bf16 v[40:43], v[72:75], v[96:99], v[40:43]
    ds_read_b64 v[86:87], v211 offset:1224
    v_mfma_f32_16x16x32_bf16 v[44:47], v[68:71], v[104:107], 0
    ds_read_b128 v[120:123], v212 offset:3264
    v_mfma_f32_16x16x32_bf16 v[44:47], v[72:75], v[100:103], v[44:47]
    ds_read_b64 v[88:89], v211 offset:704
    v_mfma_f32_16x16x32_bf16 v[48:51], v[72:75], v[104:107], 0
    ds_read_b64 v[90:91], v211 offset:712
    s_waitcnt lgkmcnt(11)
    v_mfma_f32_16x16x32_bf16 v[44:47], v[64:67], v[108:111], v[44:47]
    ds_read_b128 v[124:127], v212 offset:3776
    s_waitcnt lgkmcnt(10)
    v_mfma_f32_16x16x32_bf16 v[44:47], v[76:79], v[96:99], v[44:47]
    ds_read_b64 v[92:93], v211 offset:192
    v_mfma_f32_16x16x32_bf16 v[48:51], v[68:71], v[108:111], v[48:51]
    ds_read_b64 v[94:95], v211 offset:200
    v_mfma_f32_16x16x32_bf16 v[48:51], v[76:79], v[100:103], v[48:51]
    ds_read_b128 v[160:163], v212 offset:128
    v_mfma_f32_16x16x32_bf16 v[52:55], v[72:75], v[108:111], 0
    ds_read_b64 v[128:129], v211 offset:3712
    v_mfma_f32_16x16x32_bf16 v[52:55], v[76:79], v[104:107], v[52:55]
    ds_read_b64 v[130:131], v211 offset:3720
    v_mfma_f32_16x16x32_bf16 v[56:59], v[76:79], v[108:111], 0
    ds_read_b128 v[164:167], v212 offset:640
    s_waitcnt lgkmcnt(15)
    v_mfma_f32_16x16x32_bf16 v[48:51], v[64:67], v[112:115], v[48:51]
    ds_read_b64 v[132:133], v211 offset:3200
    s_waitcnt lgkmcnt(14)
    v_mfma_f32_16x16x32_bf16 v[48:51], v[80:83], v[96:99], v[48:51]
    ds_read_b64 v[134:135], v211 offset:3208
    v_mfma_f32_16x16x32_bf16 v[52:55], v[68:71], v[112:115], v[52:55]
    ds_read_b128 v[168:171], v212 offset:1152
    v_mfma_f32_16x16x32_bf16 v[52:55], v[80:83], v[100:103], v[52:55]
    ds_read_b64 v[136:137], v211 offset:2688
    v_mfma_f32_16x16x32_bf16 v[56:59], v[72:75], v[112:115], v[56:59]
    ds_read_b64 v[138:139], v211 offset:2696
    v_mfma_f32_16x16x32_bf16 v[56:59], v[80:83], v[104:107], v[56:59]
    ds_read_b128 v[172:175], v212 offset:1664
    v_mfma_f32_16x16x32_bf16 v[60:63], v[76:79], v[112:115], 0
    ds_read_b64 v[140:141], v211 offset:2176
    v_mfma_f32_16x16x32_bf16 v[60:63], v[80:83], v[108:111], v[60:63]
    ds_read_b64 v[142:143], v211 offset:2184
    s_waitcnt lgkmcnt(15)
    s_nop 0
    v_mfma_f32_16x16x32_bf16 v[52:55], v[64:67], v[116:119], v[52:55]
    ds_read_b128 v[176:179], v212 offset:2176
    v_mfma_f32_16x16x32_bf16 v[52:55], v[84:87], v[96:99], v[52:55]
    ds_read_b64 v[144:145], v211 offset:1664
    v_mfma_f32_16x16x32_bf16 v[56:59], v[68:71], v[116:119], v[56:59]
    ds_read_b64 v[146:147], v211 offset:1672
    v_mfma_f32_16x16x32_bf16 v[56:59], v[84:87], v[100:103], v[56:59]
    ds_read_b128 v[180:183], v212 offset:2688
    v_mfma_f32_16x16x32_bf16 v[60:63], v[72:75], v[116:119], v[60:63]
    ds_read_b64 v[148:149], v211 offset:1152
    v_mfma_f32_16x16x32_bf16 v[60:63], v[84:87], v[104:107], v[60:63]
    ds_read_b64 v[150:151], v211 offset:1160
    v_mfma_f32_16x16x32_bf16 v[56:59], v[64:67], v[120:123], v[56:59]
    ds_read_b128 v[184:187], v212 offset:3200
    v_mfma_f32_16x16x32_bf16 v[56:59], v[88:91], v[96:99], v[56:59]
    ds_read_b64 v[152:153], v211 offset:640
    v_mfma_f32_16x16x32_bf16 v[60:63], v[68:71], v[120:123], v[60:63]
    ds_read_b64 v[154:155], v211 offset:648
    v_mfma_f32_16x16x32_bf16 v[60:63], v[88:91], v[100:103], v[60:63]
    ds_read_b128 v[188:191], v212 offset:3712
    s_waitcnt lgkmcnt(15)
    v_mfma_f32_16x16x32_bf16 v[60:63], v[64:67], v[124:127], v[60:63]
    ds_read_b64 v[156:157], v211 offset:128
    v_mfma_f32_16x16x32_bf16 v[60:63], v[92:95], v[96:99], v[60:63]
    ds_read_b64 v[158:159], v211 offset:136
    s_waitcnt vmcnt(0)
    s_nop 6
    s_mov_b64 exec, 1
    s_cmp_eq_u32 s63, 0
    s_cbranch_scc1 A_yf_loc
    global_store_dword v202, v10, s[34:35] offset:64 sc1
    s_branch A_yf_done
A_yf_loc:
    global_store_dword v202, v10, s[34:35] offset:64
A_yf_done:
    s_mov_b64 exec, -1
    v_mfma_f32_16x16x32_bf16 v[32:35], v[128:131], v[160:163], v[32:35]
    ds_read_b128 v[96:99], v212 offset:64
    v_mfma_f32_16x16x32_bf16 v[36:39], v[128:131], v[164:167], v[36:39]
    ds_read_b64 v[64:65], v211 offset:3648
    v_mfma_f32_16x16x32_bf16 v[36:39], v[132:135], v[160:163], v[36:39]
    v_mfma_f32_16x16x32_bf16 v[40:43], v[132:135], v[164:167], v[40:43]
    ds_read_b64 v[66:67], v211 offset:3656
    v_mfma_f32_16x16x32_bf16 v[40:43], v[128:131], v[168:171], v[40:43]
    ds_read_b128 v[100:103], v212 offset:576
    s_waitcnt lgkmcnt(15)
    s_nop 0
    v_mfma_f32_16x16x32_bf16 v[40:43], v[136:139], v[160:163], v[40:43]
    v_mfma_f32_16x16x32_bf16 v[44:47], v[132:135], v[168:171], v[44:47]
    ds_read_b64 v[68:69], v211 offset:3136
    v_mfma_f32_16x16x32_bf16 v[44:47], v[136:139], v[164:167], v[44:47]
    ds_read_b64 v[70:71], v211 offset:3144
    v_mfma_f32_16x16x32_bf16 v[48:51], v[136:139], v[168:171], v[48:51]
    v_mfma_f32_16x16x32_bf16 v[44:47], v[128:131], v[172:175], v[44:47]
    ds_read_b128 v[104:107], v212 offset:1088
    v_mfma_f32_16x16x32_bf16 v[44:47], v[140:143], v[160:163], v[44:47]
    ds_read_b64 v[72:73], v211 offset:2624
    v_mfma_f32_16x16x32_bf16 v[48:51], v[132:135], v[172:175], v[48:51]
    v_mfma_f32_16x16x32_bf16 v[48:51], v[140:143], v[164:167], v[48:51]
    ds_read_b64 v[74:75], v211 offset:2632
    v_mfma_f32_16x16x32_bf16 v[52:55], v[136:139], v[172:175], v[52:55]
    ds_read_b128 v[108:111], v212 offset:1600
    v_mfma_f32_16x16x32_bf16 v[52:55], v[140:143], v[168:171], v[52:55]
    v_mfma_f32_16x16x32_bf16 v[56:59], v[140:143], v[172:175], v[56:59]
    ds_read_b64 v[76:77], v211 offset:2112
    v_mfma_f32_16x16x32_bf16 v[48:51], v[128:131], v[176:179], v[48:51]
    ds_read_b64 v[78:79], v211 offset:2120
    s_waitcnt lgkmcnt(15)
    s_nop 0
    v_mfma_f32_16x16x32_bf16 v[48:51], v[144:147], v[160:163], v[48:51]
    v_mfma_f32_16x16x32_bf16 v[52:55], v[132:135], v[176:179], v[52:55]
    ds_read_b128 v[112:115], v212 offset:2112
    v_mfma_f32_16x16x32_bf16 v[52:55], v[144:147], v[164:167], v[52:55]
    ds_read_b64 v[80:81], v211 offset:1600
    v_mfma_f32_16x16x32_bf16 v[56:59], v[136:139], v[176:179], v[56:59]
    v_mfma_f32_16x16x32_bf16 v[56:59], v[144:147], v[168:171], v[56:59]
    ds_read_b64 v[82:83], v211 offset:1608
    v_mfma_f32_16x16x32_bf16 v[60:63], v[140:143], v[176:179], v[60:63]
    ds_read_b128 v[116:119], v212 offset:2624
    v_mfma_f32_16x16x32_bf16 v[60:63], v[144:147], v[172:175], v[60:63]
    v_mfma_f32_16x16x32_bf16 v[52:55], v[128:131], v[180:183], v[52:55]
    ds_read_b64 v[84:85], v211 offset:1088
    v_mfma_f32_16x16x32_bf16 v[52:55], v[148:151], v[160:163], v[52:55]
    ds_read_b64 v[86:87], v211 offset:1096
    v_mfma_f32_16x16x32_bf16 v[56:59], v[132:135], v[180:183], v[56:59]
    v_mfma_f32_16x16x32_bf16 v[56:59], v[148:151], v[164:167], v[56:59]
    ds_read_b128 v[120:123], v212 offset:3136
    v_mfma_f32_16x16x32_bf16 v[60:63], v[136:139], v[180:183], v[60:63]
    ds_read_b64 v[88:89], v211 offset:576
    v_mfma_f32_16x16x32_bf16 v[60:63], v[148:151], v[168:171], v[60:63]
    v_mfma_f32_16x16x32_bf16 v[56:59], v[128:131], v[184:187], v[56:59]
    ds_read_b64 v[90:91], v211 offset:584
    v_mfma_f32_16x16x32_bf16 v[56:59], v[152:155], v[160:163], v[56:59]
    ds_read_b128 v[124:127], v212 offset:3648
    v_mfma_f32_16x16x32_bf16 v[60:63], v[132:135], v[184:187], v[60:63]
    v_mfma_f32_16x16x32_bf16 v[60:63], v[152:155], v[164:167], v[60:63]
    ds_read_b64 v[92:93], v211 offset:64
    s_waitcnt lgkmcnt(15)
    s_nop 0
    v_mfma_f32_16x16x32_bf16 v[60:63], v[128:131], v[188:191], v[60:63]
    ds_read_b64 v[94:95], v211 offset:72
    v_mfma_f32_16x16x32_bf16 v[60:63], v[156:159], v[160:163], v[60:63]
    v_mfma_f32_16x16x32_bf16 v[32:35], v[64:67], v[96:99], v[32:35]
    ds_read_b128 v[160:163], v212 offset:0
    v_mfma_f32_16x16x32_bf16 v[36:39], v[64:67], v[100:103], v[36:39]
    ds_read_b64 v[128:129], v211 offset:3584
    v_mfma_f32_16x16x32_bf16 v[36:39], v[68:71], v[96:99], v[36:39]
    v_mfma_f32_16x16x32_bf16 v[40:43], v[68:71], v[100:103], v[40:43]
    ds_read_b64 v[130:131], v211 offset:3592
    v_mfma_f32_16x16x32_bf16 v[40:43], v[64:67], v[104:107], v[40:43]
    ds_read_b128 v[164:167], v212 offset:512
    s_waitcnt lgkmcnt(15)
    s_nop 0
    v_mfma_f32_16x16x32_bf16 v[40:43], v[72:75], v[96:99], v[40:43]
    v_mfma_f32_16x16x32_bf16 v[44:47], v[68:71], v[104:107], v[44:47]
    ds_read_b64 v[132:133], v211 offset:3072
    v_mfma_f32_16x16x32_bf16 v[44:47], v[72:75], v[100:103], v[44:47]
    ds_read_b64 v[134:135], v211 offset:3080
    v_mfma_f32_16x16x32_bf16 v[48:51], v[72:75], v[104:107], v[48:51]
    v_mfma_f32_16x16x32_bf16 v[44:47], v[64:67], v[108:111], v[44:47]
    ds_read_b128 v[168:171], v212 offset:1024
    v_mfma_f32_16x16x32_bf16 v[44:47], v[76:79], v[96:99], v[44:47]
    ds_read_b64 v[136:137], v211 offset:2560
    v_mfma_f32_16x16x32_bf16 v[48:51], v[68:71], v[108:111], v[48:51]
    v_mfma_f32_16x16x32_bf16 v[48:51], v[76:79], v[100:103], v[48:51]
    ds_read_b64 v[138:139], v211 offset:2568
    v_mfma_f32_16x16x32_bf16 v[52:55], v[72:75], v[108:111], v[52:55]
    ds_read_b128 v[172:175], v212 offset:1536
    v_mfma_f32_16x16x32_bf16 v[52:55], v[76:79], v[104:107], v[52:55]
    v_mfma_f32_16x16x32_bf16 v[56:59], v[76:79], v[108:111], v[56:59]
    ds_read_b64 v[140:141], v211 offset:2048
    v_mfma_f32_16x16x32_bf16 v[48:51], v[64:67], v[112:115], v[48:51]
    ds_read_b64 v[142:143], v211 offset:2056
    s_waitcnt lgkmcnt(15)
    s_nop 0
    v_mfma_f32_16x16x32_bf16 v[48:51], v[80:83], v[96:99], v[48:51]
    v_mfma_f32_16x16x32_bf16 v[52:55], v[68:71], v[112:115], v[52:55]
    ds_read_b128 v[176:179], v212 offset:2048
    v_mfma_f32_16x16x32_bf16 v[52:55], v[80:83], v[100:103], v[52:55]
    ds_read_b64 v[144:145], v211 offset:1536
    v_mfma_f32_16x16x32_bf16 v[56:59], v[72:75], v[112:115], v[56:59]
    v_mfma_f32_16x16x32_bf16 v[56:59], v[80:83], v[104:107], v[56:59]
    ds_read_b64 v[146:147], v211 offset:1544
    v_mfma_f32_16x16x32_bf16 v[60:63], v[76:79], v[112:115], v[60:63]
    ds_read_b128 v[180:183], v212 offset:2560
    v_mfma_f32_16x16x32_bf16 v[60:63], v[80:83], v[108:111], v[60:63]
    v_mfma_f32_16x16x32_bf16 v[52:55], v[64:67], v[116:119], v[52:55]
    ds_read_b64 v[148:149], v211 offset:1024
    v_mfma_f32_16x16x32_bf16 v[52:55], v[84:87], v[96:99], v[52:55]
    ds_read_b64 v[150:151], v211 offset:1032
    v_mfma_f32_16x16x32_bf16 v[56:59], v[68:71], v[116:119], v[56:59]
    v_mfma_f32_16x16x32_bf16 v[56:59], v[84:87], v[100:103], v[56:59]
    ds_read_b128 v[184:187], v212 offset:3072
    v_mfma_f32_16x16x32_bf16 v[60:63], v[72:75], v[116:119], v[60:63]
    ds_read_b64 v[152:153], v211 offset:512
    v_mfma_f32_16x16x32_bf16 v[60:63], v[84:87], v[104:107], v[60:63]
    v_mfma_f32_16x16x32_bf16 v[56:59], v[64:67], v[120:123], v[56:59]
    ds_read_b64 v[154:155], v211 offset:520
    v_mfma_f32_16x16x32_bf16 v[56:59], v[88:91], v[96:99], v[56:59]
    ds_read_b128 v[188:191], v212 offset:3584
    v_mfma_f32_16x16x32_bf16 v[60:63], v[68:71], v[120:123], v[60:63]
    v_mfma_f32_16x16x32_bf16 v[60:63], v[88:91], v[100:103], v[60:63]
    ds_read_b64 v[156:157], v211 offset:0
    s_waitcnt lgkmcnt(15)
    s_nop 0
    v_mfma_f32_16x16x32_bf16 v[60:63], v[64:67], v[124:127], v[60:63]
    ds_read_b64 v[158:159], v211 offset:8
    v_mfma_f32_16x16x32_bf16 v[60:63], v[92:95], v[96:99], v[60:63]
    global_load_dword v224, v205, s[34:35] sc1
    v_mfma_f32_16x16x32_bf16 v[32:35], v[128:131], v[160:163], v[32:35]
    v_mfma_f32_16x16x32_bf16 v[36:39], v[128:131], v[164:167], v[36:39]
    v_mfma_f32_16x16x32_bf16 v[36:39], v[132:135], v[160:163], v[36:39]
    v_mfma_f32_16x16x32_bf16 v[40:43], v[132:135], v[164:167], v[40:43]
    v_mfma_f32_16x16x32_bf16 v[40:43], v[128:131], v[168:171], v[40:43]
    s_waitcnt lgkmcnt(15)
    v_mfma_f32_16x16x32_bf16 v[40:43], v[136:139], v[160:163], v[40:43]
    v_mfma_f32_16x16x32_bf16 v[44:47], v[132:135], v[168:171], v[44:47]
    v_mfma_f32_16x16x32_bf16 v[44:47], v[136:139], v[164:167], v[44:47]
    v_mfma_f32_16x16x32_bf16 v[48:51], v[136:139], v[168:171], v[48:51]
    s_waitcnt lgkmcnt(14)
    v_mfma_f32_16x16x32_bf16 v[44:47], v[128:131], v[172:175], v[44:47]
    s_waitcnt lgkmcnt(12)
    s_nop 0
    v_mfma_f32_16x16x32_bf16 v[44:47], v[140:143], v[160:163], v[44:47]
    v_mfma_f32_16x16x32_bf16 v[48:51], v[132:135], v[172:175], v[48:51]
    v_mfma_f32_16x16x32_bf16 v[48:51], v[140:143], v[164:167], v[48:51]
    v_mfma_f32_16x16x32_bf16 v[52:55], v[136:139], v[172:175], v[52:55]
    v_mfma_f32_16x16x32_bf16 v[52:55], v[140:143], v[168:171], v[52:55]
    v_mfma_f32_16x16x32_bf16 v[56:59], v[140:143], v[172:175], v[56:59]
    s_waitcnt lgkmcnt(11)
    v_mfma_f32_16x16x32_bf16 v[48:51], v[128:131], v[176:179], v[48:51]
    s_waitcnt lgkmcnt(9)
    v_mfma_f32_16x16x32_bf16 v[48:51], v[144:147], v[160:163], v[48:51]
    v_mfma_f32_16x16x32_bf16 v[52:55], v[132:135], v[176:179], v[52:55]
    v_mfma_f32_16x16x32_bf16 v[52:55], v[144:147], v[164:167], v[52:55]
    v_mfma_f32_16x16x32_bf16 v[56:59], v[136:139], v[176:179], v[56:59]
    v_mfma_f32_16x16x32_bf16 v[56:59], v[144:147], v[168:171], v[56:59]
    v_mfma_f32_16x16x32_bf16 v[60:63], v[140:143], v[176:179], v[60:63]
    v_mfma_f32_16x16x32_bf16 v[60:63], v[144:147], v[172:175], v[60:63]
    s_waitcnt lgkmcnt(8)
    v_mfma_f32_16x16x32_bf16 v[52:55], v[128:131], v[180:183], v[52:55]
    s_waitcnt lgkmcnt(6)
    v_mfma_f32_16x16x32_bf16 v[52:55], v[148:151], v[160:163], v[52:55]
    v_mfma_f32_16x16x32_bf16 v[56:59], v[132:135], v[180:183], v[56:59]
    v_mfma_f32_16x16x32_bf16 v[56:59], v[148:151], v[164:167], v[56:59]
    v_mfma_f32_16x16x32_bf16 v[60:63], v[136:139], v[180:183], v[60:63]
    v_mfma_f32_16x16x32_bf16 v[60:63], v[148:151], v[168:171], v[60:63]
    s_waitcnt lgkmcnt(5)
    v_mfma_f32_16x16x32_bf16 v[56:59], v[128:131], v[184:187], v[56:59]
    s_waitcnt lgkmcnt(3)
    v_mfma_f32_16x16x32_bf16 v[56:59], v[152:155], v[160:163], v[56:59]
    v_mfma_f32_16x16x32_bf16 v[60:63], v[132:135], v[184:187], v[60:63]
    v_mfma_f32_16x16x32_bf16 v[60:63], v[152:155], v[164:167], v[60:63]
    s_waitcnt lgkmcnt(2)
    v_mfma_f32_16x16x32_bf16 v[60:63], v[128:131], v[188:191], v[60:63]
    s_waitcnt lgkmcnt(0)
    v_mfma_f32_16x16x32_bf16 v[60:63], v[156:159], v[160:163], v[60:63]
    s_setprio 0
    s_waitcnt vmcnt(0)
    v_cmp_ne_u32 vcc, s45, v224
    s_nop 0
    s_cbranch_vccnz A_fy_r
A_fy_k:
    s_cmp_eq_u32 s41, 1
    s_nop 1
    s_cbranch_scc1 A_red1
    ds_write_b128 v213, v[48:51] offset:0
    ds_write_b128 v213, v[52:55] offset:1024
    ds_write_b128 v213, v[56:59] offset:2048
    ds_write_b128 v213, v[60:63] offset:3072
    s_waitcnt lgkmcnt(0)
    s_barrier
    ds_read_b128 v[72:75], v214 offset:0
    ds_read_b128 v[76:79], v214 offset:1024
    ds_read_b128 v[80:83], v214 offset:2048
    ds_read_b128 v[84:87], v214 offset:3072
    s_waitcnt lgkmcnt(3)
    v_add_f32 v32, v32, v72
    v_add_f32 v33, v33, v73
    v_add_f32 v34, v34, v74
    v_add_f32_e64 v35, v35, v75
    v_cvt_pk_bf16_f32 v192, v32, v33
    v_cvt_pk_bf16_f32 v193, v34, v35
    ds_write_b64 v216, v[192:193] offset:0
    s_waitcnt lgkmcnt(3)
    v_add_f32 v36, v36, v76
    v_add_f32 v37, v37, v77
    v_add_f32 v38, v38, v78
    v_add_f32_e64 v39, v39, v79
    v_cvt_pk_bf16_f32 v194, v36, v37
    v_cvt_pk_bf16_f32 v195, v38, v39
    ds_write_b64 v216, v[194:195] offset:512
    s_waitcnt lgkmcnt(3)
    v_add_f32 v40, v40, v80
    v_add_f32 v41, v41, v81
    v_add_f32 v42, v42, v82
    v_add_f32_e64 v43, v43, v83
    v_cvt_pk_bf16_f32 v196, v40, v41
    v_cvt_pk_bf16_f32 v197, v42, v43
    ds_write_b64 v216, v[196:197] offset:1024
    s_waitcnt lgkmcnt(3)
    v_add_f32 v44, v44, v84
    v_add_f32 v45, v45, v85
    v_add_f32 v46, v46, v86
    v_add_f32_e64 v47, v47, v87
    v_cvt_pk_bf16_f32 v198, v44, v45
    v_cvt_pk_bf16_f32 v199, v46, v47
    ds_write_b64 v216, v[198:199] offset:1536
    s_branch A_red_done
A_red1:
    ds_write_b128 v213, v[32:35] offset:0
    ds_write_b128 v213, v[36:39] offset:1024
    ds_write_b128 v213, v[40:43] offset:2048
    ds_write_b128 v213, v[44:47] offset:3072
    s_waitcnt lgkmcnt(0)
    s_barrier
    ds_read_b128 v[72:75], v214 offset:0
    ds_read_b128 v[76:79], v214 offset:1024
    ds_read_b128 v[80:83], v214 offset:2048
    ds_read_b128 v[84:87], v214 offset:3072
    s_waitcnt lgkmcnt(3)
    v_add_f32 v48, v48, v72
    v_add_f32 v49, v49, v73
    v_add_f32 v50, v50, v74
    v_add_f32 v51, v51, v75
    v_cvt_pk_bf16_f32 v192, v48, v49
    v_cvt_pk_bf16_f32 v193, v50, v51
    ds_write_b64 v216, v[192:193] offset:0
    s_waitcnt lgkmcnt(3)
    v_add_f32 v52, v52, v76
    v_add_f32 v53, v53, v77
    v_add_f32 v54, v54, v78
    v_add_f32_e64 v55, v55, v79
    v_cvt_pk_bf16_f32 v194, v52, v53
    v_cvt_pk_bf16_f32 v195, v54, v55
    ds_write_b64 v216, v[194:195] offset:512
    s_waitcnt lgkmcnt(3)
    v_add_f32 v56, v56, v80
    v_add_f32 v57, v57, v81
    v_add_f32 v58, v58, v82
    v_add_f32_e64 v59, v59, v83
    v_cvt_pk_bf16_f32 v196, v56, v57
    v_cvt_pk_bf16_f32 v197, v58, v59
    ds_write_b64 v216, v[196:197] offset:1024
    s_waitcnt lgkmcnt(3)
    v_add_f32 v60, v60, v84
    v_add_f32 v61, v61, v85
    v_add_f32 v62, v62, v86
    v_add_f32_e64 v63, v63, v87
    v_cvt_pk_bf16_f32 v198, v60, v61
    v_cvt_pk_bf16_f32 v199, v62, v63
    ds_write_b64 v216, v[198:199] offset:1536
    s_nop 0
A_red_done:
    s_waitcnt lgkmcnt(0)
    ds_read_b128 v[72:75], v217
    ds_read_b128 v[76:79], v217 offset:1024
    s_waitcnt lgkmcnt(1)
    s_waitcnt lgkmcnt(0)
    s_cmp_eq_u32 s63, 0
    s_cbranch_scc1 A_ys_loc
    global_store_dwordx4 v204, v[72:75], s[34:35] sc1
    global_store_dwordx4 v204, v[76:79], s[34:35] offset:1024 sc1
    s_branch A_ys_done
A_ys_loc:
    global_store_dwordx4 v204, v[72:75], s[34:35]
    global_store_dwordx4 v204, v[76:79], s[34:35] offset:1024
A_ys_done:
    s_waitcnt vmcnt(0)
    global_load_dwordx4 v[32:35], v218, s[34:35] sc1
    global_load_dwordx4 v[36:39], v219, s[34:35] sc1
    s_waitcnt vmcnt(0)
    v_max3_u32 v7, v32, v33, v34
    v_max3_u32 v7, v7, v35, v36
    v_max3_u32 v7, v7, v37, v38
    v_max_u32 v7, v7, v39
    v_cmp_eq_u32_e64 vcc, -1, v7
    s_nop 0
    s_cbranch_vccnz A_y_r0
A_y_k0:
    v_perm_b32 v40, v36, v32, s50
    ds_write_b32 v4, v40 offset:9216
    v_perm_b32 v41, v36, v32, s51
    ds_write_b32 v4, v41 offset:9344
    v_perm_b32 v42, v37, v33, s50
    ds_write_b32 v4, v42 offset:9472
    v_perm_b32 v43, v37, v33, s51
    ds_write_b32 v4, v43 offset:9600
    v_perm_b32 v44, v38, v34, s50
    ds_write_b32 v4, v44 offset:9728
    v_perm_b32 v45, v38, v34, s51
    ds_write_b32 v4, v45 offset:9856
    v_perm_b32 v46, v39, v35, s50
    ds_write_b32 v4, v46 offset:9984
    v_perm_b32 v47, v39, v35, s51
    ds_write_b32 v4, v47 offset:10112
    s_waitcnt lgkmcnt(0)
    s_barrier
    ds_read_b128 v[48:51], v5 offset:9216
    ds_read_b128 v[52:55], v6 offset:9216
    s_waitcnt lgkmcnt(1)
    global_store_dwordx4 v220, v[48:51], s[30:31] nt
    s_waitcnt lgkmcnt(0)
    global_store_dwordx4 v221, v[52:55], s[30:31] nt
    s_endpgm
A_fu_r:
    s_sleep 3
    global_load_dword v224, v203, s[34:35] sc1
    s_add_u32 s46, s46, 1
    s_cmp_gt_u32 s46, 400000
    s_waitcnt vmcnt(0)
    v_xor_b32 v9, v234, v224
    s_cbranch_scc1 A_fu_k
    v_cmp_lt_u32_e64 vcc, 15, v9
    s_nop 1
    s_cbranch_vccnz A_fu_r
    s_branch A_fu_k
A_fy_r:
    s_sleep 2
    global_load_dword v224, v205, s[34:35] sc1
    s_add_u32 s46, s46, 1
    s_cmp_gt_u32 s46, 400000
    s_waitcnt vmcnt(0)
    s_cbranch_scc1 A_fy_k
    v_cmp_ne_u32_e64 vcc, s45, v224
    s_nop 1
    s_cbranch_vccnz A_fy_r
    s_branch A_fy_k
A_y_r0:
    global_load_dwordx4 v[32:35], v218, s[34:35] sc1
    global_load_dwordx4 v[36:39], v219, s[34:35] sc1
    s_add_u32 s46, s46, 1
    s_cmp_gt_u32 s46, 400000
    s_waitcnt vmcnt(0)
    s_cbranch_scc1 A_y_k0
    v_max3_u32 v7, v32, v33, v34
    v_max3_u32 v7, v7, v35, v36
    v_max3_u32 v7, v7, v37, v38
    v_max_u32 v7, v7, v39
    v_cmp_eq_u32 vcc, -1, v7
    s_nop 1
    s_cbranch_vccnz A_y_r0
    s_branch A_y_k0
K_end:
    s_endpgm
K_last:

.section .rodata,"a"
.p2align 6
.amdhsa_kernel concat_heads__ssm_conv_s4__linear_kernel_hedgehog__prompt_kernel
  .amdhsa_next_free_vgpr 256
  .amdhsa_next_free_sgpr 102
  .amdhsa_accum_offset 256
  .amdhsa_group_segment_fixed_size 0
  .amdhsa_kernarg_size 128
  .amdhsa_user_sgpr_count 2
  .amdhsa_user_sgpr_kernarg_segment_ptr 1
  .amdhsa_system_sgpr_workgroup_id_x 1
.end_amdhsa_kernel
```
